```python
import torch

def _softmax(x, axis=-1):
    return torch.softmax(x, dim=axis)
def _gelu(x):
    return torch.nn.functional.gelu(x, approximate="tanh")
def _silu(x):
    return torch.nn.functional.silu(x)
def _sigmoid(x):
    return torch.sigmoid(x)
def _layernorm(x, axis=-1, eps=1e-5):
    m = x.mean(dim=axis, keepdim=True)
    v = x.var(dim=axis, keepdim=True, unbiased=False)
    return (x - m) / torch.sqrt(v + eps)
def _scatter_add(tgt, idx, src, axis=0):
    return tgt.clone().index_add_(axis, idx, src)
def _segment_sum(src, seg, n):
    out = torch.zeros((n,) + src.shape[1:], dtype=src.dtype)
    return out.index_add_(0, seg, src)
def _pad(x, pw):
    flat = tuple(v for pair in reversed(pw) for v in pair)
    return torch.nn.functional.pad(x, flat)

kernel_name = 'parallel_sum__gqa_block_cached__geglu_ffn__decode'

def setup_inputs():

    _w = (lambda a: (lambda t: t.to(torch.bfloat16) if t.is_floating_point() else t)(torch.as_tensor(a)))
    def _A_setup():
        B, Sq, D = 1, 1, 512
        Hq, Hkv, Sk, Dh = 32, 32, 4096, 128
        assert Hq % Hkv == 0, (Hq, Hkv)
        return {
            "x": _w((lambda *s: torch.randn(*s, dtype=torch.bfloat16) * 0.05)(B, Sq, D)),
            "k_cache": _w((lambda *s: torch.randn(*s, dtype=torch.bfloat16) * 3.2)(B, Hkv, Sk, Dh)),
            "v_cache": _w((lambda *s: torch.randn(*s, dtype=torch.bfloat16) * 1.6)(B, Hkv, Sk, Dh)),
            "wq": _w((lambda *s: torch.randn(*s, dtype=torch.bfloat16) * 3.2)(D, Hq * Dh) * (D ** -0.5)),
            "wo": _w((lambda *s: torch.randn(*s, dtype=torch.bfloat16) * 1.6)(Hq * Dh, D) * ((Hq * Dh) ** -0.5)),
        }
    _A_in = _A_setup()

    def _B_setup():
        B, S, D, F = 1, 1, 512, 1376
        return {
            "x": _w((lambda *s: torch.randn(*s, dtype=torch.bfloat16) * 0.05)(B, S, D)),
            "w_gate": _w((lambda *s: torch.randn(*s, dtype=torch.bfloat16) * 0.05)(D, F)),
            "w_up": _w((lambda *s: torch.randn(*s, dtype=torch.bfloat16) * 0.05)(D, F)),
            "w_down": _w((lambda *s: torch.randn(*s, dtype=torch.bfloat16) * 0.05)(F, D)),
        }
    _B_in = _B_setup()

    return {
        "A_x": _A_in["x"],
        "A_k_cache": _A_in["k_cache"],
        "A_v_cache": _A_in["v_cache"],
        "A_wq": _A_in["wq"],
        "A_wo": _A_in["wo"],
        "B_x": _B_in["x"],
        "B_w_gate": _B_in["w_gate"],
        "B_w_up": _B_in["w_up"],
        "B_w_down": _B_in["w_down"],
    }

def reference(A_x, A_k_cache, A_v_cache, A_wq, A_wo, B_x, B_w_gate, B_w_up, B_w_down):
    def _A_ref(x, k_cache, v_cache, wq, wo):
        B, Sq, D = x.shape
        Hq, Dh = 32, 128
        Hkv = k_cache.shape[1]
        rep = Hq // Hkv
        q = (lambda x, *d: x.permute(*d))((x @ wq).reshape(B, Sq, Hq, Dh), 0, 2, 1, 3)
        k = (lambda x, n, axis: torch.repeat_interleave(x, n, dim=axis))(k_cache, rep, axis=1)
        v = (lambda x, n, axis: torch.repeat_interleave(x, n, dim=axis))(v_cache, rep, axis=1)
        scores = torch.einsum("bhqd,bhkd->bhqk", q, k) * (Dh ** -0.5)
        p = _softmax(scores, axis=-1)
        o = torch.einsum("bhqk,bhkd->bhqd", p, v)
        return (lambda x, *d: x.permute(*d))(o, 0, 2, 1, 3).reshape(B, Sq, Hq * Dh) @ wo

    def _B_ref(x, w_gate, w_up, w_down):
        return (_gelu(x @ w_gate) * (x @ w_up)) @ w_down

    x = A_x
    xn = _layernorm(x, axis=-1)
    return x + _A_ref(xn, A_k_cache, A_v_cache, A_wq, A_wo) + _B_ref(xn, B_w_gate, B_w_up, B_w_down)
```

```asm
; @launch grid=(256,1,1) block=(512,1,1) lds=10240
.amdgcn_target "amdgcn-amd-amdhsa--gfx950"
.text
.globl parallel_sum__gqa_block_cached__geglu_ffn__decode_kernel
.p2align 8
.type parallel_sum__gqa_block_cached__geglu_ffn__decode_kernel,@function
parallel_sum__gqa_block_cached__geglu_ffn__decode_kernel:
  s_load_dwordx2 s[36:37], s[0:1], 8
  v_lshrrev_b32 v1, 6, v0
  s_and_b32 s3, s2, 7
  s_lshr_b32 s47, s2, 3
  v_readfirstlane_b32 s31, v1
  s_lshl_b32 s3, s3, 5
  s_or_b32 s47, s47, s3
  v_and_b32 v2, 63, v0
  s_lshl_b32 s33, s47, 5
  s_and_b32 s32, s31, 3
  v_lshlrev_b32 v3, 4, v2
  s_or_b32 s33, s33, s32
  s_lshl_b32 s33, s33, 12
  s_lshl_b32 s38, 1, 25
  s_lshl_b32 s39, 1, 17
  s_cmpk_ge_u32 s2, 256
  s_cbranch_scc1 L_end
  s_cmp_lt_u32 s31, 4
  s_cbranch_scc0 L_K
  s_branch L_V
L_K:
  s_waitcnt lgkmcnt(0)
  buffer_load_dwordx4 v[128:131], v3, s[36:39], s33 offen offset:0 nt
  buffer_load_dwordx4 v[132:135], v3, s[36:39], s33 offen offset:1024 nt
  buffer_load_dwordx4 v[136:139], v3, s[36:39], s33 offen offset:2048 nt
  buffer_load_dwordx4 v[140:143], v3, s[36:39], s33 offen offset:3072 nt
  s_addk_i32 s33, 0x4000
  buffer_load_dwordx4 v[144:147], v3, s[36:39], s33 offen offset:0 nt
  buffer_load_dwordx4 v[148:151], v3, s[36:39], s33 offen offset:1024 nt
  s_load_dwordx16 s[4:19], s[0:1], 0
  s_load_dwordx8 s[20:27], s[0:1], 64
  s_lshr_b32 s29, s47, 3
  s_and_b32 s30, s47, 7
  s_mul_i32 s44, s29, 9216
  s_mul_i32 s45, s47, 1152
  v_mov_b32 v0, 1
  v_mov_b32 v1, 0
  s_mov_b32 s42, 0x10000000
  s_mov_b32 s43, 0x20000
  v_mov_b32 v8, 0
  v_mov_b32 v9, 0
  s_mov_b64 exec, 15
  v_lshlrev_b32 v10, 3, v2
  ds_write_b64 v10, v[8:9] offset:1296
  s_mov_b64 exec, -1
  v_mov_b32 v4, -1
  v_mov_b32 v5, -1
  v_mov_b32 v6, -1
  v_mov_b32 v7, -1
  s_lshl_b32 s3, s32, 10
  s_add_u32 s34, s3, s45
  v_add_u32 v8, s3, v3
  v_cmp_gt_u32 vcc, 1152, v8
  s_cmp_ge_u32 s32, 2
  s_waitcnt lgkmcnt(0)
  s_mov_b32 s40, s26
  s_mov_b32 s41, s27
  s_cbranch_scc1 L_clr_j
  s_mov_b64 exec, vcc
  buffer_store_dwordx4 v[4:7], v3, s[40:43], s34 offen
  s_mov_b64 exec, -1
L_clr_j:
  s_mov_b32 s3, 819200
  s_load_dword s14, s[26:27], s3
  s_lshl_b32 s15, s47, 9
  s_add_u32 s15, s15, 688128
  v_lshlrev_b32 v22, 2, v2
  v_lshrrev_b32 v8, 3, v2
  v_mul_u32_u24 v30, 1152, v8
  v_mul_u32_u24 v28, 1280, v8
  s_mul_i32 s46, s29, 10240
  s_add_u32 s46, s46, 1048576
  s_waitcnt vmcnt(5)
  buffer_load_dwordx4 v[152:155], v3, s[36:39], s33 offen offset:2048 nt
  s_waitcnt vmcnt(5)
  buffer_load_dwordx4 v[156:159], v3, s[36:39], s33 offen offset:3072 nt
  s_addk_i32 s33, 0x4000
  s_waitcnt vmcnt(5)
  buffer_load_dwordx4 v[160:163], v3, s[36:39], s33 offen offset:0 nt
  s_waitcnt vmcnt(5)
  buffer_load_dwordx4 v[164:167], v3, s[36:39], s33 offen offset:1024 nt
  s_waitcnt vmcnt(5)
  buffer_load_dwordx4 v[168:171], v3, s[36:39], s33 offen offset:2048 nt
  s_waitcnt vmcnt(5)
  buffer_load_dwordx4 v[172:175], v3, s[36:39], s33 offen offset:3072 nt
  s_barrier
  s_mov_b64 exec, 1
  ds_add_u32 v1, v0 offset:1312
  s_mov_b64 exec, -1
  s_addk_i32 s33, 0x4000
  s_waitcnt vmcnt(5)
  buffer_load_dwordx4 v[176:179], v3, s[36:39], s33 offen offset:0 nt
  s_waitcnt vmcnt(5)
  buffer_load_dwordx4 v[180:183], v3, s[36:39], s33 offen offset:1024 nt
  s_waitcnt vmcnt(5)
  buffer_load_dwordx4 v[184:187], v3, s[36:39], s33 offen offset:2048 nt
  s_waitcnt vmcnt(5)
  buffer_load_dwordx4 v[188:191], v3, s[36:39], s33 offen offset:3072 nt
  s_addk_i32 s33, 0x4000
  s_waitcnt vmcnt(5)
  buffer_load_dwordx4 v[192:195], v3, s[36:39], s33 offen offset:0 nt
  s_waitcnt vmcnt(5)
  buffer_load_dwordx4 v[196:199], v3, s[36:39], s33 offen offset:1024 nt
  s_waitcnt vmcnt(5)
  buffer_load_dwordx4 v[200:203], v3, s[36:39], s33 offen offset:2048 nt
  s_waitcnt vmcnt(5)
  buffer_load_dwordx4 v[204:207], v3, s[36:39], s33 offen offset:3072 nt
  s_addk_i32 s33, 0x4000
  s_waitcnt vmcnt(5)
  buffer_load_dwordx4 v[208:211], v3, s[36:39], s33 offen offset:0 nt
  s_waitcnt vmcnt(5)
  buffer_load_dwordx4 v[212:215], v3, s[36:39], s33 offen offset:1024 nt
  s_waitcnt vmcnt(5)
  buffer_load_dwordx4 v[216:219], v3, s[36:39], s33 offen offset:2048 nt
  s_waitcnt vmcnt(5)
  buffer_load_dwordx4 v[220:223], v3, s[36:39], s33 offen offset:3072 nt
  s_addk_i32 s33, 0x4000
  s_waitcnt vmcnt(5)
  buffer_load_dwordx4 v[224:227], v3, s[36:39], s33 offen offset:0 nt
  s_waitcnt vmcnt(5)
  buffer_load_dwordx4 v[228:231], v3, s[36:39], s33 offen offset:1024 nt
  s_waitcnt vmcnt(5)
  buffer_load_dwordx4 v[232:235], v3, s[36:39], s33 offen offset:2048 nt
  s_waitcnt vmcnt(5)
  buffer_load_dwordx4 v[236:239], v3, s[36:39], s33 offen offset:3072 nt
  s_addk_i32 s33, 0x4000
  s_waitcnt vmcnt(5)
  buffer_load_dwordx4 v[240:243], v3, s[36:39], s33 offen offset:0 nt
  s_waitcnt vmcnt(5)
  buffer_load_dwordx4 v[244:247], v3, s[36:39], s33 offen offset:1024 nt
  s_mov_b64 exec, 1
  ds_add_u32 v1, v0 offset:1300
  s_mov_b64 exec, -1
  s_waitcnt vmcnt(5)
  buffer_load_dwordx4 v[248:251], v3, s[36:39], s33 offen offset:2048 nt
  s_waitcnt vmcnt(5)
  buffer_load_dwordx4 v[252:255], v3, s[36:39], s33 offen offset:3072 nt
  s_cmp_lg_u32 s32, 0
  s_cbranch_scc1 L_noq
  s_add_u32 s3, s46, 0
  buffer_load_dwordx4 v[64:67], v3, s[40:43], s3 offen offset:0 sc1
  buffer_load_dwordx4 v[68:71], v3, s[40:43], s3 offen offset:1280 sc1
  buffer_load_dwordx4 v[72:75], v3, s[40:43], s3 offen offset:2560 sc1
  s_add_u32 s3, s46, 3840
  buffer_load_dwordx4 v[76:79], v3, s[40:43], s3 offen offset:0 sc1
  buffer_load_dwordx4 v[80:83], v3, s[40:43], s3 offen offset:1280 sc1
  buffer_load_dwordx4 v[84:87], v3, s[40:43], s3 offen offset:2560 sc1
  s_add_u32 s3, s46, 7680
  buffer_load_dwordx4 v[88:91], v3, s[40:43], s3 offen offset:0 sc1
  buffer_load_dwordx4 v[92:95], v3, s[40:43], s3 offen offset:1280 sc1
  buffer_load_dwordx2 v[96:97], v28, s[40:43], s46 offen offset:1024 sc1
L_noq:
  s_mul_i32 s61, s29, 6
  s_mul_i32 s3, s29, 6
  s_add_u32 s3, s3, 0
  s_cmp_lt_u32 s29, 16
  s_cselect_b32 s61, s61, s3
  s_cselect_b32 s60, 6, 6
  v_lshrrev_b32 v8, 3, v2
  v_and_b32 v9, 7, v2
  s_lshl_b32 s3, s29, 7
  s_lshl_b32 s34, s32, 5
  s_add_u32 s3, s3, s34
  v_bfe_u32 v10, v2, 3, 1
  v_lshl_add_u32 v16, v10, 2, s3
  v_bfe_u32 v10, v2, 4, 1
  v_lshl_add_u32 v16, v10, 1, v16
  v_lshrrev_b32 v10, 5, v2
  v_add_u32 v16, v16, v10
  v_lshlrev_b32 v16, 10, v16
  s_lshl_b32 s3, s30, 7
  v_lshl_add_u32 v12, v9, 4, s3
  v_add_u32 v16, v16, v12
  s_lshl_b32 s16, s60, 1
  s_mul_i32 s17, s32, s16
  s_lshl_b32 s3, s61, 3
  s_add_u32 s3, s3, s17
  v_bfe_u32 v10, v2, 4, 1
  v_lshlrev_b32 v19, 2, v10
  v_bfe_u32 v10, v2, 3, 1
  v_lshl_add_u32 v19, v10, 1, v19
  v_lshrrev_b32 v10, 5, v2
  v_add_u32 v10, v19, v10
  v_add_u32 v17, s3, v10
  v_lshlrev_b32 v17, 10, v17
  v_add_u32 v17, v17, v12
  v_add_u32 v19, 8192, v17
  v_mov_b32 v12, 0x40000000
  v_cmp_gt_u32 vcc, s16, v10
  v_add_u32 v10, 8, v10
  v_cmp_gt_u32 s[58:59], s16, v10
  v_cndmask_b32 v17, v12, v17, vcc
  s_nop 0
  v_cndmask_b32 v19, v12, v19, s[58:59]
  s_mov_b32 s48, s12
  s_mov_b32 s49, s13
  s_mov_b32 s50, 4194304
  s_mov_b32 s51, 0x20000
  s_mov_b32 s52, s20
  s_mov_b32 s53, s21
  s_mov_b32 s54, 1409024
  s_mov_b32 s55, 0x20000
  v_lshl_add_u32 v18, v9, 1, s17
  v_lshl_add_u32 v18, v18, 2, v30
  v_lshl_add_u32 v20, v9, 2, s34
  v_lshl_add_u32 v20, v20, 2, v30
  v_lshrrev_b32 v8, 5, v2
  s_lshl_b32 s3, s32, 9
  v_lshl_add_u32 v8, v8, 8, s3
  v_lshl_add_u32 v8, v9, 5, v8
  v_and_b32 v9, 16, v2
  v_add_u32 v21, v8, v9
  v_mov_b32 v11, 0
  s_mov_b32 s56, 0x00ff00ff
  s_mov_b32 s57, 0xff00ff00
  v_and_b32 v8, 1, v2
  v_mov_b32 v9, 0xffff
  v_mov_b32 v10, 0xffff0000
  v_cmp_eq_u32 vcc, 1, v8
  v_bfe_u32 v8, v2, 1, 2
  s_waitcnt lgkmcnt(0)
  s_add_u32 s14, s14, 1
  v_cndmask_b32 v9, v9, v10, vcc
  v_cmp_eq_u32 vcc, 0, v8
  s_nop 1
  v_cndmask_b32 v32, 0, v9, vcc
  v_cmp_eq_u32 vcc, 1, v8
  s_nop 1
  v_cndmask_b32 v33, 0, v9, vcc
  v_cmp_eq_u32 vcc, 2, v8
  s_nop 1
  v_cndmask_b32 v34, 0, v9, vcc
  v_cmp_eq_u32 vcc, 3, v8
  s_nop 1
  v_cndmask_b32 v35, 0, v9, vcc
  s_cmp_lg_u32 s32, 0
  s_cbranch_scc1 L_qp_skip
  s_mov_b32 s35, 200000
  s_mov_b32 s28, 1
L_qp:
  s_waitcnt vmcnt(0)
  v_min_u32 v8, v65, v65
  v_max_u32 v9, v65, v65
  v_min3_u32 v8, v8, v67, v69
  v_max3_u32 v9, v9, v67, v69
  v_min3_u32 v8, v8, v71, v73
  v_max3_u32 v9, v9, v71, v73
  v_min3_u32 v8, v8, v75, v77
  v_max3_u32 v9, v9, v75, v77
  v_min3_u32 v8, v8, v79, v81
  v_max3_u32 v9, v9, v79, v81
  v_min3_u32 v8, v8, v83, v85
  v_max3_u32 v9, v9, v83, v85
  v_min3_u32 v8, v8, v87, v89
  v_max3_u32 v9, v9, v87, v89
  v_min3_u32 v8, v8, v91, v93
  v_max3_u32 v9, v9, v91, v93
  v_min3_u32 v8, v8, v95, v97
  v_max3_u32 v9, v9, v95, v97
  v_cmp_ne_u32 vcc, s14, v8
  v_cmp_ne_u32 s[58:59], s14, v9
  s_or_b64 vcc, vcc, s[58:59]
  s_cbranch_vccz L_qp_done
  s_sleep 8
  s_cmp_gt_u32 s35, 199976
  s_cbranch_scc1 L_qp_again
  s_cmp_eq_u32 s28, 0
  s_cbranch_scc1 L_rp1_x
  s_mov_b32 s28, 0
  s_mov_b32 s18, s35
  s_mov_b32 s35, 1600000
L_rp1:
  ds_read_b32 v10, v1 offset:1320
  s_waitcnt lgkmcnt(0)
  v_readfirstlane_b32 s3, v10
  s_cmp_ge_u32 s3, 1
  s_cbranch_scc1 L_rp1_done
  s_sleep 1
  s_sub_u32 s35, s35, 1
  s_cmp_lg_u32 s35, 0
  s_cbranch_scc1 L_rp1
L_rp1_done:
  s_mov_b32 s35, s18
  ds_read_b128 v[100:103], v3 offset:6144
  ds_read_b128 v[104:107], v3 offset:7168
  s_mul_i32 s3, s47, 1280
  s_add_u32 s3, s3, 1572864
  s_waitcnt lgkmcnt(0)
  buffer_store_dwordx4 v[100:103], v3, s[40:43], s3 offen sc1
  s_mov_b64 exec, 0xff
  buffer_store_dwordx4 v[104:107], v3, s[40:43], s3 offen offset:1024 sc1
  s_mov_b64 exec, -1
L_rp1_x:
  s_xor_b32 s46, s46, 524288
L_qp_again:
  s_add_u32 s3, s46, 0
  buffer_load_dwordx4 v[64:67], v3, s[40:43], s3 offen offset:0 sc1
  buffer_load_dwordx4 v[68:71], v3, s[40:43], s3 offen offset:1280 sc1
  buffer_load_dwordx4 v[72:75], v3, s[40:43], s3 offen offset:2560 sc1
  s_add_u32 s3, s46, 3840
  buffer_load_dwordx4 v[76:79], v3, s[40:43], s3 offen offset:0 sc1
  buffer_load_dwordx4 v[80:83], v3, s[40:43], s3 offen offset:1280 sc1
  buffer_load_dwordx4 v[84:87], v3, s[40:43], s3 offen offset:2560 sc1
  s_add_u32 s3, s46, 7680
  buffer_load_dwordx4 v[88:91], v3, s[40:43], s3 offen offset:0 sc1
  buffer_load_dwordx4 v[92:95], v3, s[40:43], s3 offen offset:1280 sc1
  buffer_load_dwordx2 v[96:97], v28, s[40:43], s46 offen offset:1024 sc1
  s_sub_u32 s35, s35, 1
  s_cmp_lg_u32 s35, 0
  s_cbranch_scc1 L_qp
  s_waitcnt vmcnt(0)
L_qp_done:
  v_add_f32 v64, v64, v68
  v_add_f32 v66, v66, v70
  v_add_f32 v72, v72, v76
  v_add_f32 v74, v74, v78
  v_add_f32 v80, v80, v84
  v_add_f32 v82, v82, v86
  v_add_f32 v88, v88, v92
  v_add_f32 v90, v90, v94
  v_add_f32 v64, v64, v72
  v_add_f32 v66, v66, v74
  v_add_f32 v80, v80, v88
  v_add_f32 v82, v82, v90
  v_add_f32 v64, v64, v80
  v_add_f32 v66, v66, v82
  s_getreg_b32 s3, hwreg(HW_REG_XCC_ID, 0, 4)
  v_cmp_ne_u32 vcc, s3, v96
  v_cvt_pk_bf16_f32 v64, v64, v66
  s_cmp_eq_u64 vcc, 0
  s_cselect_b32 s19, 1, 0
  s_cmp_lg_u32 s19, 0
  s_cbranch_scc1 L_loc
  s_cmp_eq_u32 s28, 0
  s_cbranch_scc1 L_rp2_x
  s_mov_b32 s28, 0
  s_mov_b32 s18, s35
  s_mov_b32 s35, 1600000
L_rp2:
  ds_read_b32 v10, v1 offset:1320
  s_waitcnt lgkmcnt(0)
  v_readfirstlane_b32 s3, v10
  s_cmp_ge_u32 s3, 1
  s_cbranch_scc1 L_rp2_done
  s_sleep 1
  s_sub_u32 s35, s35, 1
  s_cmp_lg_u32 s35, 0
  s_cbranch_scc1 L_rp2
L_rp2_done:
  s_mov_b32 s35, s18
  ds_read_b128 v[100:103], v3 offset:6144
  ds_read_b128 v[104:107], v3 offset:7168
  s_mul_i32 s3, s47, 1280
  s_add_u32 s3, s3, 1572864
  s_waitcnt lgkmcnt(0)
  buffer_store_dwordx4 v[100:103], v3, s[40:43], s3 offen sc1
  s_mov_b64 exec, 0xff
  buffer_store_dwordx4 v[104:107], v3, s[40:43], s3 offen offset:1024 sc1
  s_mov_b64 exec, -1
L_rp2_x:
  s_or_b32 s46, s46, 524288
  s_add_u32 s3, s45, 2097152
  buffer_store_dwordx4 v[4:7], v3, s[40:43], s3 offen sc1
  s_mov_b64 exec, 0xff
  buffer_store_dwordx4 v[4:7], v3, s[40:43], s3 offen offset:1024 sc1
  s_mul_i32 s3, s47, 1280
  s_add_u32 s3, s3, 1572864
  v_mov_b32 v8, s14
  v_mov_b32 v9, s14
  s_mov_b64 exec, 1
  s_waitcnt vmcnt(0)
  buffer_store_dwordx2 v[8:9], v1, s[40:43], s3 offen offset:1152 sc1
  s_mov_b64 exec, -1
  s_mov_b32 s35, 200000
L_br:
  buffer_load_dwordx2 v[8:9], v28, s[40:43], s46 offen offset:1152 sc1
  s_waitcnt vmcnt(0)
  v_cmp_ne_u32 vcc, s14, v9
  s_cbranch_vccz L_loc
  s_sleep 8
  s_sub_u32 s35, s35, 1
  s_cmp_lg_u32 s35, 0
  s_cbranch_scc1 L_br
L_loc:
  v_mov_b32 v66, s19
  ds_write_b32 v1, v66 offset:1280
  ds_write_b32 v22, v64 offset:1024
  s_waitcnt lgkmcnt(0)
  ds_write_b32 v1, v0 offset:1296
L_qp_skip:
  v_and_b32 v9, 15, v2
  v_lshlrev_b32 v9, 4, v9
  s_mov_b32 s35, 1600000
L_qf:
  ds_read_b32 v10, v1 offset:1296
  s_waitcnt lgkmcnt(0)
  v_readfirstlane_b32 s3, v10
  s_cmp_ge_u32 s3, 1
  s_cbranch_scc1 L_qf_done
  s_sleep 2
  s_sub_u32 s35, s35, 1
  s_cmp_lg_u32 s35, 0
  s_cbranch_scc1 L_qf
L_qf_done:
  ds_read_b128 v[4:7], v9 offset:1024
  ds_read_b32 v8, v1 offset:1280
  s_waitcnt lgkmcnt(0)
  v_readfirstlane_b32 s28, v8
  s_cmp_lg_u32 s28, 0
  s_cselect_b32 s3, 0, 2097152
  s_add_u32 s44, s44, s3
  s_add_u32 s45, s45, s3
  s_lshl_b32 s3, s28, 2
  s_add_u32 s3, s3, s32
  s_cmp_lg_u32 s3, 1
  s_cbranch_scc1 L_nogu
  s_mov_b32 s35, 1600000
L_gw:
  ds_read_b32 v10, v1 offset:1320
  s_waitcnt lgkmcnt(0)
  v_readfirstlane_b32 s3, v10
  s_cmp_ge_u32 s3, 1
  s_cbranch_scc1 L_gw_done
  s_sleep 1
  s_sub_u32 s35, s35, 1
  s_cmp_lg_u32 s35, 0
  s_cbranch_scc1 L_gw
L_gw_done:
  s_mov_b32 exec_hi, 0
  ds_read_b128 v[12:15], v3 offset:3072
  s_waitcnt lgkmcnt(0)
  buffer_store_dwordx4 v[12:15], v3, s[40:43], s45 offen offset:0 sc1
  s_mov_b32 exec_hi, -1
L_nogu:
  buffer_load_dwordx2 v[24:25], v18, s[40:43], s44 offen offset:0 sc1
  buffer_load_dwordx2 v[26:27], v18, s[40:43], s44 offen offset:256 sc1
  s_waitcnt vmcnt(2)
  v_dot2_f32_bf16 v64, v128, v4, 0
  v_dot2_f32_bf16 v65, v132, v4, 0
  v_dot2_f32_bf16 v66, v136, v4, 0
  v_dot2_f32_bf16 v67, v140, v4, 0
  v_dot2_f32_bf16 v68, v144, v4, 0
  v_dot2_f32_bf16 v69, v148, v4, 0
  v_dot2_f32_bf16 v70, v152, v4, 0
  v_dot2_f32_bf16 v71, v156, v4, 0
  v_dot2_f32_bf16 v64, v129, v5, v64
  v_dot2_f32_bf16 v65, v133, v5, v65
  v_dot2_f32_bf16 v66, v137, v5, v66
  v_dot2_f32_bf16 v67, v141, v5, v67
  v_dot2_f32_bf16 v68, v145, v5, v68
  v_dot2_f32_bf16 v69, v149, v5, v69
  v_dot2_f32_bf16 v70, v153, v5, v70
  v_dot2_f32_bf16 v71, v157, v5, v71
  v_dot2_f32_bf16 v64, v130, v6, v64
  v_dot2_f32_bf16 v65, v134, v6, v65
  v_dot2_f32_bf16 v66, v138, v6, v66
  v_dot2_f32_bf16 v67, v142, v6, v67
  v_dot2_f32_bf16 v68, v146, v6, v68
  v_dot2_f32_bf16 v69, v150, v6, v69
  v_dot2_f32_bf16 v70, v154, v6, v70
  v_dot2_f32_bf16 v71, v158, v6, v71
  v_dot2_f32_bf16 v64, v131, v7, v64
  v_dot2_f32_bf16 v65, v135, v7, v65
  v_dot2_f32_bf16 v66, v139, v7, v66
  v_dot2_f32_bf16 v67, v143, v7, v67
  v_dot2_f32_bf16 v68, v147, v7, v68
  v_dot2_f32_bf16 v69, v151, v7, v69
  v_dot2_f32_bf16 v70, v155, v7, v70
  v_dot2_f32_bf16 v71, v159, v7, v71
  v_dot2_f32_bf16 v72, v160, v4, 0
  v_dot2_f32_bf16 v73, v164, v4, 0
  v_dot2_f32_bf16 v74, v168, v4, 0
  v_dot2_f32_bf16 v75, v172, v4, 0
  v_dot2_f32_bf16 v76, v176, v4, 0
  v_dot2_f32_bf16 v77, v180, v4, 0
  v_dot2_f32_bf16 v78, v184, v4, 0
  v_dot2_f32_bf16 v79, v188, v4, 0
  v_dot2_f32_bf16 v72, v161, v5, v72
  v_dot2_f32_bf16 v73, v165, v5, v73
  v_dot2_f32_bf16 v74, v169, v5, v74
  v_dot2_f32_bf16 v75, v173, v5, v75
  v_dot2_f32_bf16 v76, v177, v5, v76
  v_dot2_f32_bf16 v77, v181, v5, v77
  v_dot2_f32_bf16 v78, v185, v5, v78
  v_dot2_f32_bf16 v79, v189, v5, v79
  v_dot2_f32_bf16 v72, v162, v6, v72
  v_dot2_f32_bf16 v73, v166, v6, v73
  v_dot2_f32_bf16 v74, v170, v6, v74
  v_dot2_f32_bf16 v75, v174, v6, v75
  v_dot2_f32_bf16 v76, v178, v6, v76
  v_dot2_f32_bf16 v77, v182, v6, v77
  v_dot2_f32_bf16 v78, v186, v6, v78
  v_dot2_f32_bf16 v79, v190, v6, v79
  v_dot2_f32_bf16 v72, v163, v7, v72
  v_dot2_f32_bf16 v73, v167, v7, v73
  v_dot2_f32_bf16 v74, v171, v7, v74
  v_dot2_f32_bf16 v75, v175, v7, v75
  v_dot2_f32_bf16 v76, v179, v7, v76
  v_dot2_f32_bf16 v77, v183, v7, v77
  v_dot2_f32_bf16 v78, v187, v7, v78
  v_dot2_f32_bf16 v79, v191, v7, v79
  v_dot2_f32_bf16 v80, v192, v4, 0
  v_dot2_f32_bf16 v81, v196, v4, 0
  v_dot2_f32_bf16 v82, v200, v4, 0
  v_dot2_f32_bf16 v83, v204, v4, 0
  v_dot2_f32_bf16 v84, v208, v4, 0
  v_dot2_f32_bf16 v85, v212, v4, 0
  v_dot2_f32_bf16 v86, v216, v4, 0
  v_dot2_f32_bf16 v87, v220, v4, 0
  v_dot2_f32_bf16 v80, v193, v5, v80
  v_dot2_f32_bf16 v81, v197, v5, v81
  v_dot2_f32_bf16 v82, v201, v5, v82
  v_dot2_f32_bf16 v83, v205, v5, v83
  v_dot2_f32_bf16 v84, v209, v5, v84
  v_dot2_f32_bf16 v85, v213, v5, v85
  v_dot2_f32_bf16 v86, v217, v5, v86
  v_dot2_f32_bf16 v87, v221, v5, v87
  v_dot2_f32_bf16 v80, v194, v6, v80
  v_dot2_f32_bf16 v81, v198, v6, v81
  v_dot2_f32_bf16 v82, v202, v6, v82
  v_dot2_f32_bf16 v83, v206, v6, v83
  v_dot2_f32_bf16 v84, v210, v6, v84
  v_dot2_f32_bf16 v85, v214, v6, v85
  v_dot2_f32_bf16 v86, v218, v6, v86
  v_dot2_f32_bf16 v87, v222, v6, v87
  v_dot2_f32_bf16 v80, v195, v7, v80
  v_dot2_f32_bf16 v81, v199, v7, v81
  v_dot2_f32_bf16 v82, v203, v7, v82
  v_dot2_f32_bf16 v83, v207, v7, v83
  v_dot2_f32_bf16 v84, v211, v7, v84
  v_dot2_f32_bf16 v85, v215, v7, v85
  v_dot2_f32_bf16 v86, v219, v7, v86
  v_dot2_f32_bf16 v87, v223, v7, v87
  v_dot2_f32_bf16 v88, v224, v4, 0
  v_dot2_f32_bf16 v89, v228, v4, 0
  v_dot2_f32_bf16 v90, v232, v4, 0
  v_dot2_f32_bf16 v91, v236, v4, 0
  v_dot2_f32_bf16 v92, v240, v4, 0
  v_dot2_f32_bf16 v93, v244, v4, 0
  v_dot2_f32_bf16 v94, v248, v4, 0
  v_dot2_f32_bf16 v95, v252, v4, 0
  v_dot2_f32_bf16 v88, v225, v5, v88
  v_dot2_f32_bf16 v89, v229, v5, v89
  v_dot2_f32_bf16 v90, v233, v5, v90
  v_dot2_f32_bf16 v91, v237, v5, v91
  v_dot2_f32_bf16 v92, v241, v5, v92
  v_dot2_f32_bf16 v93, v245, v5, v93
  v_dot2_f32_bf16 v94, v249, v5, v94
  v_dot2_f32_bf16 v95, v253, v5, v95
  v_dot2_f32_bf16 v88, v226, v6, v88
  v_dot2_f32_bf16 v89, v230, v6, v89
  v_dot2_f32_bf16 v90, v234, v6, v90
  v_dot2_f32_bf16 v91, v238, v6, v91
  v_dot2_f32_bf16 v92, v242, v6, v92
  v_dot2_f32_bf16 v93, v246, v6, v93
  v_dot2_f32_bf16 v94, v250, v6, v94
  v_dot2_f32_bf16 v95, v254, v6, v95
  v_dot2_f32_bf16 v88, v227, v7, v88
  v_dot2_f32_bf16 v89, v231, v7, v89
  v_dot2_f32_bf16 v90, v235, v7, v90
  v_dot2_f32_bf16 v91, v239, v7, v91
  v_dot2_f32_bf16 v92, v243, v7, v92
  v_dot2_f32_bf16 v93, v247, v7, v93
  v_dot2_f32_bf16 v94, v251, v7, v94
  v_dot2_f32_bf16 v95, v255, v7, v95
  s_nop 1
  v_add_f32_dpp v64, v64, v64 row_shl:8 row_mask:0xf bank_mask:0x3
  v_add_f32_dpp v65, v65, v65 row_shl:8 row_mask:0xf bank_mask:0x3
  v_add_f32_dpp v66, v66, v66 row_shl:8 row_mask:0xf bank_mask:0x3
  v_add_f32_dpp v67, v67, v67 row_shl:8 row_mask:0xf bank_mask:0x3
  v_add_f32_dpp v68, v68, v68 row_shl:8 row_mask:0xf bank_mask:0x3
  v_add_f32_dpp v69, v69, v69 row_shl:8 row_mask:0xf bank_mask:0x3
  v_add_f32_dpp v70, v70, v70 row_shl:8 row_mask:0xf bank_mask:0x3
  v_add_f32_dpp v71, v71, v71 row_shl:8 row_mask:0xf bank_mask:0x3
  v_add_f32_dpp v72, v72, v72 row_shl:8 row_mask:0xf bank_mask:0x3
  v_add_f32_dpp v73, v73, v73 row_shl:8 row_mask:0xf bank_mask:0x3
  v_add_f32_dpp v74, v74, v74 row_shl:8 row_mask:0xf bank_mask:0x3
  v_add_f32_dpp v75, v75, v75 row_shl:8 row_mask:0xf bank_mask:0x3
  v_add_f32_dpp v76, v76, v76 row_shl:8 row_mask:0xf bank_mask:0x3
  v_add_f32_dpp v77, v77, v77 row_shl:8 row_mask:0xf bank_mask:0x3
  v_add_f32_dpp v78, v78, v78 row_shl:8 row_mask:0xf bank_mask:0x3
  v_add_f32_dpp v79, v79, v79 row_shl:8 row_mask:0xf bank_mask:0x3
  v_add_f32_dpp v64, v80, v80 row_shr:8 row_mask:0xf bank_mask:0xc
  v_add_f32_dpp v65, v81, v81 row_shr:8 row_mask:0xf bank_mask:0xc
  v_add_f32_dpp v66, v82, v82 row_shr:8 row_mask:0xf bank_mask:0xc
  v_add_f32_dpp v67, v83, v83 row_shr:8 row_mask:0xf bank_mask:0xc
  v_add_f32_dpp v68, v84, v84 row_shr:8 row_mask:0xf bank_mask:0xc
  v_add_f32_dpp v69, v85, v85 row_shr:8 row_mask:0xf bank_mask:0xc
  v_add_f32_dpp v70, v86, v86 row_shr:8 row_mask:0xf bank_mask:0xc
  v_add_f32_dpp v71, v87, v87 row_shr:8 row_mask:0xf bank_mask:0xc
  v_add_f32_dpp v72, v88, v88 row_shr:8 row_mask:0xf bank_mask:0xc
  v_add_f32_dpp v73, v89, v89 row_shr:8 row_mask:0xf bank_mask:0xc
  v_add_f32_dpp v74, v90, v90 row_shr:8 row_mask:0xf bank_mask:0xc
  v_add_f32_dpp v75, v91, v91 row_shr:8 row_mask:0xf bank_mask:0xc
  v_add_f32_dpp v76, v92, v92 row_shr:8 row_mask:0xf bank_mask:0xc
  v_add_f32_dpp v77, v93, v93 row_shr:8 row_mask:0xf bank_mask:0xc
  v_add_f32_dpp v78, v94, v94 row_shr:8 row_mask:0xf bank_mask:0xc
  v_add_f32_dpp v79, v95, v95 row_shr:8 row_mask:0xf bank_mask:0xc
  v_add_f32_dpp v64, v64, v64 row_shl:4 row_mask:0xf bank_mask:0x5
  v_add_f32_dpp v65, v65, v65 row_shl:4 row_mask:0xf bank_mask:0x5
  v_add_f32_dpp v66, v66, v66 row_shl:4 row_mask:0xf bank_mask:0x5
  v_add_f32_dpp v67, v67, v67 row_shl:4 row_mask:0xf bank_mask:0x5
  v_add_f32_dpp v68, v68, v68 row_shl:4 row_mask:0xf bank_mask:0x5
  v_add_f32_dpp v69, v69, v69 row_shl:4 row_mask:0xf bank_mask:0x5
  v_add_f32_dpp v70, v70, v70 row_shl:4 row_mask:0xf bank_mask:0x5
  v_add_f32_dpp v71, v71, v71 row_shl:4 row_mask:0xf bank_mask:0x5
  v_add_f32_dpp v64, v72, v72 row_shr:4 row_mask:0xf bank_mask:0xa
  v_add_f32_dpp v65, v73, v73 row_shr:4 row_mask:0xf bank_mask:0xa
  v_add_f32_dpp v66, v74, v74 row_shr:4 row_mask:0xf bank_mask:0xa
  v_add_f32_dpp v67, v75, v75 row_shr:4 row_mask:0xf bank_mask:0xa
  v_add_f32_dpp v68, v76, v76 row_shr:4 row_mask:0xf bank_mask:0xa
  v_add_f32_dpp v69, v77, v77 row_shr:4 row_mask:0xf bank_mask:0xa
  v_add_f32_dpp v70, v78, v78 row_shr:4 row_mask:0xf bank_mask:0xa
  v_add_f32_dpp v71, v79, v79 row_shr:4 row_mask:0xf bank_mask:0xa
  v_and_b32 v8, 2, v2
  v_cmp_ne_u32 vcc, 0, v8
  v_add_f32_dpp v64, v64, v64 quad_perm:[2,3,0,1] row_mask:0xf bank_mask:0xf
  v_add_f32_dpp v65, v65, v65 quad_perm:[2,3,0,1] row_mask:0xf bank_mask:0xf
  v_add_f32_dpp v66, v66, v66 quad_perm:[2,3,0,1] row_mask:0xf bank_mask:0xf
  v_add_f32_dpp v67, v67, v67 quad_perm:[2,3,0,1] row_mask:0xf bank_mask:0xf
  v_add_f32_dpp v68, v68, v68 quad_perm:[2,3,0,1] row_mask:0xf bank_mask:0xf
  v_add_f32_dpp v69, v69, v69 quad_perm:[2,3,0,1] row_mask:0xf bank_mask:0xf
  v_add_f32_dpp v70, v70, v70 quad_perm:[2,3,0,1] row_mask:0xf bank_mask:0xf
  v_add_f32_dpp v71, v71, v71 quad_perm:[2,3,0,1] row_mask:0xf bank_mask:0xf
  v_cndmask_b32 v64, v64, v68, vcc
  v_cndmask_b32 v65, v65, v69, vcc
  v_cndmask_b32 v66, v66, v70, vcc
  v_cndmask_b32 v67, v67, v71, vcc
  v_and_b32 v8, 1, v2
  v_cmp_ne_u32 vcc, 0, v8
  v_add_f32_dpp v64, v64, v64 quad_perm:[1,0,3,2] row_mask:0xf bank_mask:0xf
  v_add_f32_dpp v65, v65, v65 quad_perm:[1,0,3,2] row_mask:0xf bank_mask:0xf
  v_add_f32_dpp v66, v66, v66 quad_perm:[1,0,3,2] row_mask:0xf bank_mask:0xf
  v_add_f32_dpp v67, v67, v67 quad_perm:[1,0,3,2] row_mask:0xf bank_mask:0xf
  v_cndmask_b32 v64, v64, v66, vcc
  v_cndmask_b32 v65, v65, v67, vcc
  v_cvt_pk_bf16_f32 v8, v64, v65
  v_lshlrev_b32 v64, 16, v8
  v_and_b32 v65, 0xffff0000, v8
  v_mul_f32 v64, 0x3db504f3, v64
  v_mul_f32 v65, 0x3db504f3, v65
  v_cvt_pk_bf16_f32 v8, v64, v65
  v_lshlrev_b32 v64, 16, v8
  v_and_b32 v65, 0xffff0000, v8
  v_max_f32 v12, v64, v65
  s_nop 1
  v_max_f32_dpp v12, v12, v12 row_ror:8 row_mask:0xf bank_mask:0xf
  s_nop 1
  v_max_f32_dpp v12, v12, v12 row_ror:4 row_mask:0xf bank_mask:0xf
  s_nop 1
  v_max_f32_dpp v12, v12, v12 row_ror:2 row_mask:0xf bank_mask:0xf
  s_nop 1
  v_max_f32_dpp v12, v12, v12 row_ror:1 row_mask:0xf bank_mask:0xf
  v_mov_b32 v13, v12
  s_nop 1
  v_permlane16_swap_b32 v12, v13
  v_max_f32 v12, v12, v13
  v_mov_b32 v13, v12
  s_nop 1
  v_permlane32_swap_b32 v12, v13
  v_max_f32 v12, v12, v13
  v_sub_f32 v64, v64, v12
  v_sub_f32 v65, v65, v12
  v_mul_f32 v64, 1069066811, v64
  v_mul_f32 v65, 1069066811, v65
  v_exp_f32 v64, v64
  v_exp_f32 v65, v65
  s_lshl_b32 s3, s32, 8
  v_lshl_add_u32 v9, v2, 2, s3
  v_cvt_pk_bf16_f32 v8, v64, v65
  v_add_f32 v13, v64, v65
  ds_write_b32 v9, v8 offset:2048
  v_mul_f32 v12, 1069066811, v12
  s_nop 1
  v_add_f32_dpp v13, v13, v13 row_ror:8 row_mask:0xf bank_mask:0xf
  s_nop 1
  v_add_f32_dpp v13, v13, v13 row_ror:4 row_mask:0xf bank_mask:0xf
  s_nop 1
  v_add_f32_dpp v13, v13, v13 row_ror:2 row_mask:0xf bank_mask:0xf
  s_nop 1
  v_add_f32_dpp v13, v13, v13 row_ror:1 row_mask:0xf bank_mask:0xf
  v_mov_b32 v14, v13
  s_nop 1
  v_permlane16_swap_b32 v13, v14
  v_add_f32 v13, v13, v14
  v_mov_b32 v14, v13
  s_nop 1
  v_permlane32_swap_b32 v13, v14
  v_add_f32 v13, v13, v14
  s_lshl_b32 s3, s32, 3
  v_mov_b32 v9, s3
  s_mov_b64 exec, 1
  ds_write_b64 v9, v[12:13] offset:1536
  s_waitcnt lgkmcnt(0)
  ds_add_rtn_u32 v8, v1, v0 offset:1304
  s_waitcnt lgkmcnt(0)
  v_readfirstlane_b32 s3, v8
  s_mov_b64 exec, 0xff
  s_cmp_lg_u32 s3, 3
  s_cbranch_scc1 L_noml
  ds_read_b128 v[56:59], v1 offset:1536
  ds_read_b128 v[60:63], v1 offset:1552
  s_waitcnt lgkmcnt(0)
  v_max_f32 v12, v56, v58
  v_max3_f32 v12, v12, v60, v62
  v_sub_f32 v56, v56, v12
  v_sub_f32 v58, v58, v12
  v_sub_f32 v60, v60, v12
  v_sub_f32 v62, v62, v12
  v_exp_f32 v56, v56
  v_exp_f32 v58, v58
  v_exp_f32 v60, v60
  v_exp_f32 v62, v62
  v_mul_f32 v13, v56, v57
  v_fmac_f32 v13, v58, v59
  v_fmac_f32 v13, v60, v61
  v_fmac_f32 v13, v62, v63
  s_cmp_lg_u32 s28, 0
  s_cbranch_scc0 L_ml_far
  buffer_store_dwordx4 v[12:15], v3, s[40:43], s45 offen offset:1024
L_ml_j:
L_noml:
  s_mov_b64 exec, -1
  s_lshr_b32 s3, s29, 2
  s_sub_u32 s34, s32, 1
  s_cmp_lt_u32 s34, 2
  s_cselect_b32 s16, s30, 99
  s_cmp_eq_u32 s3, s16
  s_cselect_b32 s16, 1, 0
  s_cbranch_scc0 L_nofin
  v_lshrrev_b32 v8, 2, v2
  v_and_b32 v9, 3, v2
  v_lshlrev_b32 v14, 12, v8
  v_lshl_add_u32 v14, v9, 4, v14
  s_and_b32 s3, s29, 3
  s_lshl_b32 s3, s3, 1
  s_add_u32 s3, s3, s34
  s_lshl_b32 s3, s3, 6
  s_lshl_b32 s46, s30, 9
  s_add_u32 s46, s46, s3
  s_add_u32 s46, s46, 688128
  s_add_u32 s47, s46, 65536
  v_lshrrev_b32 v11, 5, v2
  v_lshl_add_u32 v11, v9, 1, v11
  s_lshl_b32 s3, s29, 1
  s_add_u32 s3, s3, s34
  s_lshl_b32 s3, s3, 3
  v_add_u32 v11, s3, v11
  v_lshlrev_b32 v11, 1, v11
  global_load_ushort v12, v11, s[4:5]
  v_and_b32 v8, 28, v2
  v_cmp_eq_u32 s[60:61], 0, v8
  s_nop 0
  s_mov_b64 exec, s[60:61]
  global_store_short v11, v1, s[22:23]
  s_mov_b64 exec, -1
L_nofin:
  s_mov_b32 s35, 200000
L_gu:
  s_waitcnt vmcnt(0)
  v_permlane32_swap_b32 v24, v25
  v_permlane32_swap_b32 v26, v27
  v_add_f32 v24, v24, v25
  v_add_f32 v26, v26, v27
  v_mov_b32 v25, v24
  v_mov_b32 v27, v26
  s_nop 0
  v_permlane16_swap_b32 v24, v25
  v_permlane16_swap_b32 v26, v27
  v_add_f32 v24, v24, v25
  v_add_f32 v26, v26, v27
  s_nop 0
  v_add_f32_dpp v24, v24, v24 row_ror:8 row_mask:0xf bank_mask:0xf
  v_add_f32_dpp v26, v26, v26 row_ror:8 row_mask:0xf bank_mask:0xf
  v_cmp_u_f32 vcc, v24, v26
  s_cbranch_vccz L_gu_done
  s_sleep 8
  buffer_load_dwordx2 v[24:25], v18, s[40:43], s44 offen offset:0 sc1
  buffer_load_dwordx2 v[26:27], v18, s[40:43], s44 offen offset:256 sc1
  s_sub_u32 s35, s35, 1
  s_cmp_lg_u32 s35, 0
  s_cbranch_scc1 L_gu
L_gu_done:
  v_cvt_pk_bf16_f32 v8, v24, v26
  v_lshlrev_b32 v24, 16, v8
  v_and_b32 v26, 0xffff0000, v8
  s_mov_b32 s3, 0x3d372713
  v_mul_f32 v8, v24, v24
  v_fma_f32 v8, v8, s3, 1.0
  v_mul_f32 v8, v8, v24
  v_mul_f32 v8, 0xc0135761, v8
  v_exp_f32 v8, v8
  s_nop 0
  v_add_f32 v8, 1.0, v8
  v_rcp_f32 v8, v8
  s_nop 0
  v_mul_f32 v8, v8, v24
  v_cvt_pk_bf16_f32 v8, v8, v8
  v_and_b32 v8, 0xffff0000, v8
  v_mul_f32 v8, v8, v26
  v_cvt_pk_bf16_f32 v8, v8, v8
  s_nop 1
  v_mov_b32_dpp v24, v8 row_newbcast:0 row_mask:5 bank_mask:3
  v_mov_b32_dpp v25, v8 row_newbcast:4 row_mask:5 bank_mask:3
  s_nop 0
  v_mov_b32_dpp v24, v8 row_newbcast:1 row_mask:5 bank_mask:12
  v_mov_b32_dpp v25, v8 row_newbcast:5 row_mask:5 bank_mask:12
  s_nop 0
  v_mov_b32_dpp v24, v8 row_newbcast:2 row_mask:10 bank_mask:3
  v_mov_b32_dpp v25, v8 row_newbcast:6 row_mask:10 bank_mask:3
  s_nop 0
  v_mov_b32_dpp v24, v8 row_newbcast:3 row_mask:10 bank_mask:12
  v_mov_b32_dpp v25, v8 row_newbcast:7 row_mask:10 bank_mask:12
  s_nop 0
  v_and_b32 v40, v24, v32
  v_and_b32 v41, v24, v33
  v_and_b32 v42, v24, v34
  v_and_b32 v43, v24, v35
  v_and_b32 v44, v25, v32
  v_and_b32 v45, v25, v33
  v_and_b32 v46, v25, v34
  v_and_b32 v47, v25, v35
  v_mov_b32 v23, s14
  v_lshrrev_b32 v8, 3, v2
  v_cmp_ne_u32 s[18:19], s30, v8
  v_and_b32 v8, 7, v2
  s_lshl_b32 s3, s32, 7
  v_lshl_add_u32 v29, v8, 4, s3
  s_mov_b32 s35, 200000
  s_not_b64 s[58:59], s[18:19]
  s_mov_b32 s35, 1600000
L_vi:
  ds_read_b32 v10, v1 offset:1308
  s_waitcnt lgkmcnt(0)
  v_readfirstlane_b32 s3, v10
  s_cmp_ge_u32 s3, 4
  s_cbranch_scc1 L_vi_done
  s_sub_u32 s35, s35, 1
  s_cmp_lg_u32 s35, 0
  s_cbranch_scc1 L_vi
L_vi_done:
  buffer_load_dwordx4 v[112:115], v17, s[52:55], 0 offen nt
  buffer_load_dwordx4 v[116:119], v19, s[52:55], 0 offen nt
  s_mov_b32 s3, 0
  buffer_load_dwordx4 v[96:99], v16, s[48:51], s3 offen nt
  s_mov_b32 s3, 8192
  buffer_load_dwordx4 v[100:103], v16, s[48:51], s3 offen nt
  s_mov_b32 s3, 16384
  buffer_load_dwordx4 v[104:107], v16, s[48:51], s3 offen nt
  s_mov_b32 s3, 24576
  buffer_load_dwordx4 v[108:111], v16, s[48:51], s3 offen nt
  v_lshlrev_b32 v19, 3, v2
  s_mov_b32 s35, 200000
  s_barrier
  s_mov_b64 exec, s[58:59]
  ds_read_b128 v[64:67], v29 offset:8192
  ds_read_b128 v[68:71], v29 offset:8704
  ds_read_b128 v[72:75], v29 offset:9216
  ds_read_b128 v[76:79], v29 offset:9728
  s_cmp_lg_u32 s28, 0
  s_waitcnt lgkmcnt(2)
  v_add_f32 v64, v64, v68
  v_add_f32 v65, v65, v69
  v_add_f32 v66, v66, v70
  v_add_f32 v67, v67, v71
  s_waitcnt lgkmcnt(0)
  v_add_f32 v72, v72, v76
  v_add_f32 v73, v73, v77
  v_add_f32 v74, v74, v78
  v_add_f32 v75, v75, v79
  v_add_f32 v80, v64, v72
  v_add_f32 v81, v65, v73
  v_add_f32 v82, v66, v74
  v_add_f32 v83, v67, v75
  s_cbranch_scc0 L_op_far
  buffer_store_dwordx4 v[80:83], v20, s[40:43], s44 offen offset:512
L_op_j:
  s_mov_b64 exec, -1
  buffer_load_dwordx2 v[56:57], v30, s[40:43], s44 offen offset:1024 sc1
  s_mov_b64 exec, s[18:19]
  buffer_load_dwordx4 v[80:83], v20, s[40:43], s44 offen offset:512 sc1
  s_mov_b64 exec, -1
  s_waitcnt vmcnt(0)
L_op_w:
  v_cmp_u_f32 vcc, v57, v57
  v_cmp_u_f32 s[58:59], v83, v83
  s_or_b64 exec, vcc, s[58:59]
  s_cbranch_execnz L_op_more
L_op_have:
  s_mov_b64 exec, -1
  v_max_f32_dpp v8, v56, v56 row_ror:8 row_mask:0xf bank_mask:0xf
  v_mov_b32 v9, v8
  s_nop 1
  v_permlane16_swap_b32 v8, v9
  v_max_f32 v8, v8, v9
  v_mov_b32 v9, v8
  s_nop 1
  v_permlane32_swap_b32 v8, v9
  v_max_f32 v8, v8, v9
  v_sub_f32 v8, v56, v8
  v_exp_f32 v8, v8
  s_nop 0
  v_mul_f32 v28, v8, v57
  v_mul_f32 v24, v80, v8
  v_mul_f32 v25, v81, v8
  v_mul_f32 v26, v82, v8
  v_mul_f32 v27, v83, v8
  v_add_f32_dpp v28, v28, v28 row_ror:8 row_mask:0xf bank_mask:0xf
  v_permlane32_swap_b32 v24, v25
  v_mov_b32 v9, v28
  v_permlane32_swap_b32 v26, v27
  v_add_f32 v24, v24, v25
  v_permlane16_swap_b32 v28, v9
  v_add_f32 v26, v26, v27
  v_add_f32 v28, v28, v9
  s_nop 0
  v_mov_b32 v9, v28
  v_permlane16_swap_b32 v24, v26
  v_add_f32 v24, v24, v26
  v_permlane32_swap_b32 v28, v9
  v_add_f32 v28, v28, v9
  v_add_f32_dpp v24, v24, v24 row_ror:8 row_mask:0xf bank_mask:0xf
  v_rcp_f32 v28, v28
  s_nop 0
  v_mul_f32 v24, v24, v28
  v_cmp_u_f32 vcc, v24, v24
  v_cvt_pk_bf16_f32 v24, v24, v24
  s_cbranch_vccnz L_op_nan
L_op_done:
  s_nop 0
  v_mov_b32_dpp v60, v24 row_newbcast:0 row_mask:0xf bank_mask:0x3
  v_mov_b32_dpp v61, v24 row_newbcast:2 row_mask:0xf bank_mask:0x3
  v_mov_b32_dpp v62, v24 row_newbcast:4 row_mask:0xf bank_mask:0x3
  v_mov_b32_dpp v63, v24 row_newbcast:6 row_mask:0xf bank_mask:0x3
  v_mov_b32_dpp v60, v24 row_newbcast:1 row_mask:0xf bank_mask:0xc
  v_mov_b32_dpp v61, v24 row_newbcast:3 row_mask:0xf bank_mask:0xc
  v_mov_b32_dpp v62, v24 row_newbcast:5 row_mask:0xf bank_mask:0xc
  v_mov_b32_dpp v63, v24 row_newbcast:7 row_mask:0xf bank_mask:0xc
  v_and_b32 v64, v60, v32
  v_and_b32 v65, v60, v33
  v_and_b32 v66, v60, v34
  v_and_b32 v67, v60, v35
  s_waitcnt vmcnt(5)
  v_mfma_f32_16x16x32_bf16 v[48:51], v[40:43], v[112:115], 0
  v_and_b32 v68, v61, v32
  v_and_b32 v69, v61, v33
  v_and_b32 v70, v61, v34
  v_and_b32 v71, v61, v35
  v_mfma_f32_16x16x32_bf16 v[48:51], v[44:47], v[116:119], v[48:51]
  v_and_b32 v72, v62, v32
  v_and_b32 v73, v62, v33
  v_and_b32 v74, v62, v34
  v_and_b32 v75, v62, v35
  v_and_b32 v76, v63, v32
  v_and_b32 v77, v63, v33
  v_and_b32 v78, v63, v34
  v_and_b32 v79, v63, v35
  s_cmp_eq_u32 s32, 0
  s_waitcnt vmcnt(4)
  v_mfma_f32_16x16x32_bf16 v[48:51], v[64:67], v[96:99], v[48:51]
  s_waitcnt vmcnt(3)
  v_mfma_f32_16x16x32_bf16 v[48:51], v[68:71], v[100:103], v[48:51]
  s_waitcnt vmcnt(2)
  v_mfma_f32_16x16x32_bf16 v[48:51], v[72:75], v[104:107], v[48:51]
  s_waitcnt vmcnt(1)
  v_mfma_f32_16x16x32_bf16 v[48:51], v[76:79], v[108:111], v[48:51]
  s_mov_b64 exec, s[56:57]
  s_nop 6
  ds_write_b128 v21, v[48:51] offset:4096
  s_mov_b64 exec, -1
  s_waitcnt lgkmcnt(0)
  s_barrier
  s_cbranch_scc0 L_K_other
  ds_read2st64_b32 v[8:9], v22 offset0:16 offset1:17
  ds_read2st64_b32 v[10:11], v22 offset0:18 offset1:19
  ds_read2st64_b32 v[12:13], v22 offset0:20 offset1:21
  ds_read2st64_b32 v[14:15], v22 offset0:22 offset1:23
  s_waitcnt lgkmcnt(2)
  v_add_f32 v8, v8, v9
  v_add_f32 v10, v10, v11
  v_add_f32 v8, v8, v10
  s_waitcnt lgkmcnt(0)
  v_add_f32 v12, v12, v13
  v_add_f32 v14, v14, v15
  v_add_f32 v12, v12, v14
  v_add_f32 v22, v8, v12
  buffer_store_dwordx2 v[22:23], v19, s[40:43], s15 offen sc1
  s_endpgm
L_K_other:
  s_cmp_eq_u32 s16, 0
  s_cbranch_scc1 L_K_end
  s_mov_b32 s35, 200000
L_yp:
  buffer_load_dwordx4 v[64:67], v14, s[40:43], s46 offen sc1
  buffer_load_dwordx4 v[68:71], v14, s[40:43], s47 offen sc1
  s_waitcnt vmcnt(1)
  v_cmp_ne_u32 vcc, s14, v65
  v_cmp_ne_u32 s[58:59], s14, v67
  s_waitcnt vmcnt(0)
  v_cmp_ne_u32 s[18:19], s14, v69
  v_cmp_ne_u32 s[56:57], s14, v71
  s_or_b64 vcc, vcc, s[58:59]
  s_or_b64 s[18:19], s[18:19], s[56:57]
  s_or_b64 exec, vcc, s[18:19]
  s_cbranch_execnz L_yp_more
L_yp_have:
  s_mov_b64 exec, -1
  v_add_f32 v72, v64, v68
  v_add_f32 v73, v66, v70
  v_lshlrev_b32 v13, 16, v12
  s_nop 0
  v_permlane32_swap_b32 v72, v73
  v_add_f32 v72, v72, v73
  v_mov_b32 v73, v72
  s_nop 1
  v_permlane16_swap_b32 v72, v73
  v_add_f32 v72, v72, v73
  s_nop 1
  v_add_f32_dpp v72, v72, v72 row_ror:8 row_mask:0xf bank_mask:0xf
  s_nop 1
  v_add_f32_dpp v72, v72, v72 row_ror:4 row_mask:0xf bank_mask:0xf
  v_add_f32 v72, v72, v13
  v_cvt_pk_bf16_f32 v72, v72, v72
L_yp_done:
  s_mov_b64 exec, s[60:61]
  global_store_short v11, v72, s[22:23] nt
  s_lshl_b32 s3, s29, 2
  s_add_u32 s3, s3, s32
  s_cmp_lg_u32 s3, 1
  s_cbranch_scc1 L_K_end
  s_mov_b64 exec, 1
  v_mov_b32 v8, s14
  s_mov_b32 s3, 819200
  buffer_store_dword v8, v1, s[40:43], s3 offen
L_K_end:
L_end:
  s_endpgm
L_ml_far:
  buffer_store_dwordx4 v[12:15], v3, s[40:43], s45 offen offset:1024 sc1
  s_branch L_ml_j
L_op_far:
  buffer_store_dwordx4 v[80:83], v20, s[40:43], s44 offen offset:512 sc1
  s_branch L_op_j
L_op_more:
  s_sub_u32 s35, s35, 1
  s_cmp_eq_u32 s35, 0
  s_cbranch_scc1 L_op_have
  s_cbranch_vccz L_op1
L_op:
  buffer_load_dwordx2 v[56:57], v30, s[40:43], s44 offen offset:1024 sc1
L_op1:
  buffer_load_dwordx4 v[80:83], v20, s[40:43], s44 offen offset:512 sc1
  s_waitcnt vmcnt(0)
  s_branch L_op_w
L_op_nan:
  s_cmp_le_u32 s35, 1
  s_cbranch_scc1 L_op_done
  s_sub_u32 s35, s35, 1
  s_branch L_op
L_yp_more:
  s_sub_u32 s35, s35, 1
  s_cmp_lg_u32 s35, 0
  s_cbranch_scc1 L_yp
  s_branch L_yp_have
L_V:
  s_load_dwordx16 s[4:19], s[0:1], 0
  s_load_dwordx8 s[20:27], s[0:1], 64
  s_lshr_b32 s29, s47, 3
  s_and_b32 s30, s47, 7
  s_mul_i32 s44, s29, 9216
  s_mul_i32 s45, s47, 1152
  v_mov_b32 v0, 1
  v_mov_b32 v1, 0
  s_mov_b32 s42, 0x10000000
  s_mov_b32 s43, 0x20000
  s_cmp_lg_u32 s32, 0
  s_cbranch_scc1 L_V_other
  v_lshrrev_b32 v8, 4, v2
  v_and_b32 v9, 15, v2
  s_lshl_b32 s3, s30, 6
  v_lshl_add_u32 v10, v8, 4, s3
  v_lshlrev_b32 v11, 13, v10
  v_lshl_add_u32 v11, v9, 4, v11
  s_lshl_b32 s46, s29, 8
  s_waitcnt lgkmcnt(0)
  global_load_dwordx4 v[4:7], v3, s[4:5]
  s_mov_b32 s48, s10
  s_mov_b32 s49, s11
  s_mov_b32 s50, 4194304
  s_mov_b32 s51, 0x20000
  buffer_load_dwordx4 v[128:131], v11, s[48:51], s46 offen nt
  s_add_u32 s46, s46, 8192
  buffer_load_dwordx4 v[132:135], v11, s[48:51], s46 offen nt
  s_add_u32 s46, s46, 8192
  buffer_load_dwordx4 v[136:139], v11, s[48:51], s46 offen nt
  s_add_u32 s46, s46, 8192
  buffer_load_dwordx4 v[140:143], v11, s[48:51], s46 offen nt
  s_add_u32 s46, s46, 8192
  buffer_load_dwordx4 v[144:147], v11, s[48:51], s46 offen nt
  s_add_u32 s46, s46, 8192
  buffer_load_dwordx4 v[148:151], v11, s[48:51], s46 offen nt
  s_add_u32 s46, s46, 8192
  buffer_load_dwordx4 v[152:155], v11, s[48:51], s46 offen nt
  s_add_u32 s46, s46, 8192
  buffer_load_dwordx4 v[156:159], v11, s[48:51], s46 offen nt
  s_add_u32 s46, s46, 8192
  buffer_load_dwordx4 v[160:163], v11, s[48:51], s46 offen nt
  s_add_u32 s46, s46, 8192
  buffer_load_dwordx4 v[164:167], v11, s[48:51], s46 offen nt
  s_add_u32 s46, s46, 8192
  buffer_load_dwordx4 v[168:171], v11, s[48:51], s46 offen nt
  s_add_u32 s46, s46, 8192
  buffer_load_dwordx4 v[172:175], v11, s[48:51], s46 offen nt
  s_add_u32 s46, s46, 8192
  buffer_load_dwordx4 v[176:179], v11, s[48:51], s46 offen nt
  s_add_u32 s46, s46, 8192
  buffer_load_dwordx4 v[180:183], v11, s[48:51], s46 offen nt
  s_add_u32 s46, s46, 8192
  buffer_load_dwordx4 v[184:187], v11, s[48:51], s46 offen nt
  s_add_u32 s46, s46, 8192
  buffer_load_dwordx4 v[188:191], v11, s[48:51], s46 offen nt
  s_mov_b32 s3, 819200
  s_load_dword s14, s[26:27], s3
  s_mul_i32 s61, s29, 6
  s_mul_i32 s3, s29, 6
  s_add_u32 s3, s3, 0
  s_cmp_lt_u32 s29, 16
  s_cselect_b32 s61, s61, s3
  s_cselect_b32 s60, 6, 6
  v_and_b32 v12, 7, v9
  s_sub_u32 s3, s60, 1
  v_min_u32 v12, s3, v12
  v_add_u32 v12, s61, v12
  v_min_u32 v12, 171, v12
  v_mul_u32_u24 v13, 2752, v10
  v_lshl_add_u32 v12, v12, 4, v13
  v_add_u32 v12, 2752, v12
  v_mov_b32 v13, 0
  v_cmp_lt_u32 vcc, 7, v9
  v_mov_b32 v14, s16
  v_mov_b32 v15, s17
  v_mov_b32 v16, s18
  v_mov_b32 v17, s19
  v_cndmask_b32 v14, v14, v16, vcc
  v_cndmask_b32 v15, v15, v17, vcc
  v_lshl_add_u64 v[14:15], v[12:13], 0, v[14:15]
  s_mov_b64 s[52:53], 8256
  v_mov_b32 v64, v14
  v_mov_b32 v65, v15
  s_mov_b32 s40, s26
  s_mov_b32 s41, s27
  v_and_b32 v8, 1, v2
  v_mov_b32 v9, 0x0c0c0100
  v_mov_b32 v10, 0x01000c0c
  v_cmp_eq_u32 vcc, 1, v8
  v_mov_b32 v11, 0x0c0c0302
  v_mov_b32 v12, 0x03020c0c
  v_cndmask_b32 v9, v9, v10, vcc
  v_cndmask_b32 v11, v11, v12, vcc
  v_bfe_u32 v8, v2, 1, 3
  v_mov_b32 v10, 0x0c0c0c0c
  v_cmp_eq_u32 vcc, 0, v8
  s_nop 1
  v_cndmask_b32 v32, v10, v9, vcc
  v_cndmask_b32 v33, v10, v11, vcc
  v_cmp_eq_u32 vcc, 1, v8
  s_nop 1
  v_cndmask_b32 v34, v10, v9, vcc
  v_cndmask_b32 v35, v10, v11, vcc
  v_cmp_eq_u32 vcc, 2, v8
  s_nop 1
  v_cndmask_b32 v36, v10, v9, vcc
  v_cndmask_b32 v37, v10, v11, vcc
  v_cmp_eq_u32 vcc, 3, v8
  s_nop 1
  v_cndmask_b32 v38, v10, v9, vcc
  v_cndmask_b32 v39, v10, v11, vcc
  v_and_b32 v9, 15, v2
  v_lshlrev_b32 v9, 5, v9
  v_and_b32 v10, 16, v2
  v_add_u32 v31, v9, v10
  s_barrier
  s_waitcnt vmcnt(16)
  v_lshlrev_b32 v8, 16, v4
  v_and_b32 v9, 0xffff0000, v4
  v_lshlrev_b32 v10, 16, v5
  v_and_b32 v11, 0xffff0000, v5
  v_lshlrev_b32 v12, 16, v6
  v_and_b32 v13, 0xffff0000, v6
  v_lshlrev_b32 v14, 16, v7
  v_and_b32 v15, 0xffff0000, v7
  v_add_f32 v16, v8, v9
  v_add_f32 v17, v10, v11
  v_add_f32 v18, v12, v13
  v_add_f32 v19, v14, v15
  v_add_f32 v16, v16, v17
  v_add_f32 v18, v18, v19
  v_add_f32 v16, v16, v18
  s_nop 1
  v_add_f32_dpp v16, v16, v16 row_ror:8 row_mask:0xf bank_mask:0xf
  s_nop 1
  v_add_f32_dpp v16, v16, v16 row_ror:4 row_mask:0xf bank_mask:0xf
  s_nop 1
  v_add_f32_dpp v16, v16, v16 row_ror:2 row_mask:0xf bank_mask:0xf
  s_nop 1
  v_add_f32_dpp v16, v16, v16 row_ror:1 row_mask:0xf bank_mask:0xf
  v_mov_b32 v17, v16
  s_nop 1
  v_permlane16_swap_b32 v16, v17
  v_add_f32 v16, v16, v17
  v_mov_b32 v17, v16
  s_nop 1
  v_permlane32_swap_b32 v16, v17
  v_add_f32 v16, v16, v17
  v_mul_f32 v16, 0x3b000000, v16
  v_sub_f32 v18, v8, v16
  v_mul_f32 v17, v18, v18
  v_sub_f32 v18, v9, v16
  v_fmac_f32 v17, v18, v18
  v_sub_f32 v18, v10, v16
  v_fmac_f32 v17, v18, v18
  v_sub_f32 v18, v11, v16
  v_fmac_f32 v17, v18, v18
  v_sub_f32 v18, v12, v16
  v_fmac_f32 v17, v18, v18
  v_sub_f32 v18, v13, v16
  v_fmac_f32 v17, v18, v18
  v_sub_f32 v18, v14, v16
  v_fmac_f32 v17, v18, v18
  v_sub_f32 v18, v15, v16
  v_fmac_f32 v17, v18, v18
  s_nop 1
  v_add_f32_dpp v17, v17, v17 row_ror:8 row_mask:0xf bank_mask:0xf
  s_nop 1
  v_add_f32_dpp v17, v17, v17 row_ror:4 row_mask:0xf bank_mask:0xf
  s_nop 1
  v_add_f32_dpp v17, v17, v17 row_ror:2 row_mask:0xf bank_mask:0xf
  s_nop 1
  v_add_f32_dpp v17, v17, v17 row_ror:1 row_mask:0xf bank_mask:0xf
  v_mov_b32 v18, v17
  s_nop 1
  v_permlane16_swap_b32 v17, v18
  v_add_f32 v17, v17, v18
  v_mov_b32 v18, v17
  s_nop 1
  v_permlane32_swap_b32 v17, v18
  v_add_f32 v17, v17, v18
  v_mul_f32 v17, 0x3b000000, v17
  v_cvt_pk_bf16_f32 v16, v16, v17
  v_and_b32 v17, 0xffff0000, v16
  v_lshlrev_b32 v16, 16, v16
  v_add_f32 v17, 0x3727c5ac, v17
  v_cvt_pk_bf16_f32 v17, v17, v17
  v_and_b32 v17, 0xffff0000, v17
  v_sqrt_f32 v17, v17
  s_nop 0
  v_cvt_pk_bf16_f32 v17, v17, v17
  v_and_b32 v17, 0xffff0000, v17
  v_rcp_f32 v18, v17
  v_sub_f32 v8, v8, v16
  v_sub_f32 v9, v9, v16
  v_cvt_pk_bf16_f32 v19, v8, v9
  v_lshlrev_b32 v8, 16, v19
  v_and_b32 v9, 0xffff0000, v19
  v_mul_f32 v19, v8, v18
  v_mul_f32 v20, v9, v18
  v_fma_f32 v8, -v19, v17, v8
  v_fma_f32 v9, -v20, v17, v9
  v_fma_f32 v19, v8, v18, v19
  v_fma_f32 v20, v9, v18, v20
  v_cvt_pk_bf16_f32 v4, v19, v20
  v_sub_f32 v10, v10, v16
  v_sub_f32 v11, v11, v16
  v_cvt_pk_bf16_f32 v19, v10, v11
  v_lshlrev_b32 v10, 16, v19
  v_and_b32 v11, 0xffff0000, v19
  v_mul_f32 v19, v10, v18
  v_mul_f32 v20, v11, v18
  v_fma_f32 v10, -v19, v17, v10
  v_fma_f32 v11, -v20, v17, v11
  v_fma_f32 v19, v10, v18, v19
  v_fma_f32 v20, v11, v18, v20
  v_cvt_pk_bf16_f32 v5, v19, v20
  v_sub_f32 v12, v12, v16
  v_sub_f32 v13, v13, v16
  v_cvt_pk_bf16_f32 v19, v12, v13
  v_lshlrev_b32 v12, 16, v19
  v_and_b32 v13, 0xffff0000, v19
  v_mul_f32 v19, v12, v18
  v_mul_f32 v20, v13, v18
  v_fma_f32 v12, -v19, v17, v12
  v_fma_f32 v13, -v20, v17, v13
  v_fma_f32 v19, v12, v18, v19
  v_fma_f32 v20, v13, v18, v20
  v_cvt_pk_bf16_f32 v6, v19, v20
  v_sub_f32 v14, v14, v16
  v_sub_f32 v15, v15, v16
  v_cvt_pk_bf16_f32 v19, v14, v15
  v_lshlrev_b32 v14, 16, v19
  v_and_b32 v15, 0xffff0000, v19
  v_mul_f32 v19, v14, v18
  v_mul_f32 v20, v15, v18
  v_fma_f32 v14, -v19, v17, v14
  v_fma_f32 v15, -v20, v17, v15
  v_fma_f32 v19, v14, v18, v19
  v_fma_f32 v20, v15, v18, v20
  v_cvt_pk_bf16_f32 v7, v19, v20
  ds_write_b128 v3, v[4:7] offset:0
  v_lshrrev_b32 v8, 4, v2
  s_lshl_b32 s3, s30, 7
  v_lshl_add_u32 v8, v8, 5, s3
  s_waitcnt lgkmcnt(0)
  ds_read_b128 v[16:19], v8 offset:0
  ds_read_b128 v[20:23], v8 offset:16
  s_add_u32 s14, s14, 1
  s_mul_i32 s46, s47, 1280
  s_add_u32 s46, s46, 1048576
  s_getreg_b32 s3, hwreg(HW_REG_XCC_ID, 0, 4)
  v_mov_b32 v57, s14
  v_mov_b32 v59, s14
  v_mov_b32 v61, s14
  v_mov_b32 v63, s14
  v_mov_b32 v24, s3
  v_cmp_gt_u32 vcc, 32, v2
  v_lshlrev_b32 v25, 1, v31
  v_add_u32 v26, 512, v3
  s_waitcnt lgkmcnt(0)
  v_cndmask_b32 v26, v26, v25, vcc
  s_waitcnt vmcnt(0)
  global_load_dwordx4 v[192:195], v[64:65], off offset:-2752 nt
  global_load_dwordx4 v[196:199], v[64:65], off offset:0 nt
  global_load_dwordx4 v[200:203], v[64:65], off offset:2752 nt
  v_lshl_add_u64 v[64:65], v[64:65], 0, s[52:53]
  global_load_dwordx4 v[204:207], v[64:65], off offset:-2752 nt
  global_load_dwordx4 v[208:211], v[64:65], off offset:0 nt
  global_load_dwordx4 v[212:215], v[64:65], off offset:2752 nt
  v_lshl_add_u64 v[64:65], v[64:65], 0, s[52:53]
  global_load_dwordx4 v[216:219], v[64:65], off offset:-2752 nt
  global_load_dwordx4 v[220:223], v[64:65], off offset:0 nt
  global_load_dwordx4 v[224:227], v[64:65], off offset:2752 nt
  v_lshl_add_u64 v[64:65], v[64:65], 0, s[52:53]
  global_load_dwordx4 v[228:231], v[64:65], off offset:-2752 nt
  global_load_dwordx4 v[232:235], v[64:65], off offset:0 nt
  global_load_dwordx4 v[236:239], v[64:65], off offset:2752 nt
  v_lshl_add_u64 v[64:65], v[64:65], 0, s[52:53]
  global_load_dwordx4 v[240:243], v[64:65], off offset:-2752 nt
  global_load_dwordx4 v[244:247], v[64:65], off offset:0 nt
  global_load_dwordx4 v[248:251], v[64:65], off offset:2752 nt
  v_lshl_add_u64 v[64:65], v[64:65], 0, s[52:53]
  global_load_dwordx4 v[252:255], v[64:65], off offset:-2752 nt
  v_perm_b32 v40, v16, v16, v32
  v_perm_b32 v41, v16, v16, v34
  v_perm_b32 v42, v16, v16, v36
  v_perm_b32 v43, v16, v16, v38
  s_nop 0
  s_waitcnt vmcnt(16)
  v_mfma_f32_16x16x32_bf16 v[48:51], v[40:43], v[128:131], 0
  v_perm_b32 v44, v16, v16, v33
  v_perm_b32 v45, v16, v16, v35
  v_perm_b32 v46, v16, v16, v37
  v_perm_b32 v47, v16, v16, v39
  s_nop 1
  v_mfma_f32_16x16x32_bf16 v[48:51], v[44:47], v[132:135], v[48:51]
  v_perm_b32 v40, v17, v17, v32
  v_perm_b32 v41, v17, v17, v34
  v_perm_b32 v42, v17, v17, v36
  v_perm_b32 v43, v17, v17, v38
  s_nop 1
  v_mfma_f32_16x16x32_bf16 v[48:51], v[40:43], v[136:139], v[48:51]
  v_perm_b32 v44, v17, v17, v33
  v_perm_b32 v45, v17, v17, v35
  v_perm_b32 v46, v17, v17, v37
  v_perm_b32 v47, v17, v17, v39
  s_nop 1
  v_mfma_f32_16x16x32_bf16 v[48:51], v[44:47], v[140:143], v[48:51]
  v_perm_b32 v40, v18, v18, v32
  v_perm_b32 v41, v18, v18, v34
  v_perm_b32 v42, v18, v18, v36
  v_perm_b32 v43, v18, v18, v38
  s_nop 1
  v_mfma_f32_16x16x32_bf16 v[48:51], v[40:43], v[144:147], v[48:51]
  v_perm_b32 v44, v18, v18, v33
  v_perm_b32 v45, v18, v18, v35
  v_perm_b32 v46, v18, v18, v37
  v_perm_b32 v47, v18, v18, v39
  s_nop 1
  v_mfma_f32_16x16x32_bf16 v[48:51], v[44:47], v[148:151], v[48:51]
  v_perm_b32 v40, v19, v19, v32
  v_perm_b32 v41, v19, v19, v34
  v_perm_b32 v42, v19, v19, v36
  v_perm_b32 v43, v19, v19, v38
  s_nop 1
  v_mfma_f32_16x16x32_bf16 v[48:51], v[40:43], v[152:155], v[48:51]
  v_perm_b32 v44, v19, v19, v33
  v_perm_b32 v45, v19, v19, v35
  v_perm_b32 v46, v19, v19, v37
  v_perm_b32 v47, v19, v19, v39
  s_nop 1
  v_mfma_f32_16x16x32_bf16 v[48:51], v[44:47], v[156:159], v[48:51]
  v_perm_b32 v40, v20, v20, v32
  v_perm_b32 v41, v20, v20, v34
  v_perm_b32 v42, v20, v20, v36
  v_perm_b32 v43, v20, v20, v38
  s_nop 1
  v_mfma_f32_16x16x32_bf16 v[48:51], v[40:43], v[160:163], v[48:51]
  v_perm_b32 v44, v20, v20, v33
  v_perm_b32 v45, v20, v20, v35
  v_perm_b32 v46, v20, v20, v37
  v_perm_b32 v47, v20, v20, v39
  s_nop 1
  v_mfma_f32_16x16x32_bf16 v[48:51], v[44:47], v[164:167], v[48:51]
  v_perm_b32 v40, v21, v21, v32
  v_perm_b32 v41, v21, v21, v34
  v_perm_b32 v42, v21, v21, v36
  v_perm_b32 v43, v21, v21, v38
  s_nop 1
  v_mfma_f32_16x16x32_bf16 v[48:51], v[40:43], v[168:171], v[48:51]
  v_perm_b32 v44, v21, v21, v33
  v_perm_b32 v45, v21, v21, v35
  v_perm_b32 v46, v21, v21, v37
  v_perm_b32 v47, v21, v21, v39
  s_nop 1
  v_mfma_f32_16x16x32_bf16 v[48:51], v[44:47], v[172:175], v[48:51]
  v_perm_b32 v40, v22, v22, v32
  v_perm_b32 v41, v22, v22, v34
  v_perm_b32 v42, v22, v22, v36
  v_perm_b32 v43, v22, v22, v38
  s_nop 1
  v_mfma_f32_16x16x32_bf16 v[48:51], v[40:43], v[176:179], v[48:51]
  v_perm_b32 v44, v22, v22, v33
  v_perm_b32 v45, v22, v22, v35
  v_perm_b32 v46, v22, v22, v37
  v_perm_b32 v47, v22, v22, v39
  s_nop 1
  v_mfma_f32_16x16x32_bf16 v[48:51], v[44:47], v[180:183], v[48:51]
  v_perm_b32 v40, v23, v23, v32
  v_perm_b32 v41, v23, v23, v34
  v_perm_b32 v42, v23, v23, v36
  v_perm_b32 v43, v23, v23, v38
  s_nop 1
  v_mfma_f32_16x16x32_bf16 v[48:51], v[40:43], v[184:187], v[48:51]
  v_perm_b32 v44, v23, v23, v33
  v_perm_b32 v45, v23, v23, v35
  v_perm_b32 v46, v23, v23, v37
  v_perm_b32 v47, v23, v23, v39
  s_nop 1
  v_mfma_f32_16x16x32_bf16 v[48:51], v[44:47], v[188:191], v[48:51]
  s_mov_b32 s35, 1600000
L_clr:
  ds_read_b32 v10, v1 offset:1312
  s_waitcnt lgkmcnt(0)
  v_readfirstlane_b32 s3, v10
  s_cmp_ge_u32 s3, 4
  s_cbranch_scc1 L_clr_done
  s_sleep 1
  s_sub_u32 s35, s35, 1
  s_cmp_lg_u32 s35, 0
  s_cbranch_scc1 L_clr
L_clr_done:
  s_nop 1
  v_cndmask_b32 v56, v24, v48, vcc
  v_cndmask_b32 v58, v24, v49, vcc
  v_mov_b32 v60, v50
  v_mov_b32 v62, v51
  s_mov_b32 exec_hi, 0xff
  buffer_store_dwordx4 v[56:59], v26, s[40:43], s46 offen
  ds_write_b128 v26, v[56:59] offset:6144
  s_mov_b32 exec_hi, 0
  buffer_store_dwordx4 v[60:63], v25, s[40:43], s46 offen offset:16
  ds_write_b128 v25, v[60:63] offset:6160
  s_mov_b32 exec_hi, -1
  v_perm_b32 v40, v16, v16, v32
  v_perm_b32 v41, v16, v16, v34
  v_perm_b32 v42, v16, v16, v36
  v_perm_b32 v43, v16, v16, v38
  s_nop 0
  s_waitcnt vmcnt(2)
  v_mfma_f32_16x16x32_bf16 v[52:55], v[40:43], v[192:195], 0
  v_perm_b32 v44, v16, v16, v33
  v_perm_b32 v45, v16, v16, v35
  v_perm_b32 v46, v16, v16, v37
  v_perm_b32 v47, v16, v16, v39
  s_nop 1
  v_mfma_f32_16x16x32_bf16 v[52:55], v[44:47], v[196:199], v[52:55]
  v_perm_b32 v40, v17, v17, v32
  v_perm_b32 v41, v17, v17, v34
  v_perm_b32 v42, v17, v17, v36
  v_perm_b32 v43, v17, v17, v38
  s_nop 1
  v_mfma_f32_16x16x32_bf16 v[52:55], v[40:43], v[200:203], v[52:55]
  v_perm_b32 v44, v17, v17, v33
  v_perm_b32 v45, v17, v17, v35
  v_perm_b32 v46, v17, v17, v37
  v_perm_b32 v47, v17, v17, v39
  s_nop 1
  v_mfma_f32_16x16x32_bf16 v[52:55], v[44:47], v[204:207], v[52:55]
  v_perm_b32 v40, v18, v18, v32
  v_perm_b32 v41, v18, v18, v34
  v_perm_b32 v42, v18, v18, v36
  v_perm_b32 v43, v18, v18, v38
  s_nop 1
  v_mfma_f32_16x16x32_bf16 v[52:55], v[40:43], v[208:211], v[52:55]
  v_perm_b32 v44, v18, v18, v33
  v_perm_b32 v45, v18, v18, v35
  v_perm_b32 v46, v18, v18, v37
  v_perm_b32 v47, v18, v18, v39
  s_nop 1
  v_mfma_f32_16x16x32_bf16 v[52:55], v[44:47], v[212:215], v[52:55]
  v_perm_b32 v40, v19, v19, v32
  v_perm_b32 v41, v19, v19, v34
  v_perm_b32 v42, v19, v19, v36
  v_perm_b32 v43, v19, v19, v38
  s_nop 1
  v_mfma_f32_16x16x32_bf16 v[52:55], v[40:43], v[216:219], v[52:55]
  v_perm_b32 v44, v19, v19, v33
  v_perm_b32 v45, v19, v19, v35
  v_perm_b32 v46, v19, v19, v37
  v_perm_b32 v47, v19, v19, v39
  s_nop 1
  v_mfma_f32_16x16x32_bf16 v[52:55], v[44:47], v[220:223], v[52:55]
  v_perm_b32 v40, v20, v20, v32
  v_perm_b32 v41, v20, v20, v34
  v_perm_b32 v42, v20, v20, v36
  v_perm_b32 v43, v20, v20, v38
  s_nop 1
  v_mfma_f32_16x16x32_bf16 v[52:55], v[40:43], v[224:227], v[52:55]
  v_perm_b32 v44, v20, v20, v33
  v_perm_b32 v45, v20, v20, v35
  v_perm_b32 v46, v20, v20, v37
  v_perm_b32 v47, v20, v20, v39
  s_nop 1
  v_mfma_f32_16x16x32_bf16 v[52:55], v[44:47], v[228:231], v[52:55]
  v_perm_b32 v40, v21, v21, v32
  v_perm_b32 v41, v21, v21, v34
  v_perm_b32 v42, v21, v21, v36
  v_perm_b32 v43, v21, v21, v38
  s_nop 1
  v_mfma_f32_16x16x32_bf16 v[52:55], v[40:43], v[232:235], v[52:55]
  v_perm_b32 v44, v21, v21, v33
  v_perm_b32 v45, v21, v21, v35
  v_perm_b32 v46, v21, v21, v37
  v_perm_b32 v47, v21, v21, v39
  s_nop 1
  v_mfma_f32_16x16x32_bf16 v[52:55], v[44:47], v[236:239], v[52:55]
  v_perm_b32 v40, v22, v22, v32
  v_perm_b32 v41, v22, v22, v34
  v_perm_b32 v42, v22, v22, v36
  v_perm_b32 v43, v22, v22, v38
  s_nop 1
  v_mfma_f32_16x16x32_bf16 v[52:55], v[40:43], v[240:243], v[52:55]
  v_perm_b32 v44, v22, v22, v33
  v_perm_b32 v45, v22, v22, v35
  v_perm_b32 v46, v22, v22, v37
  v_perm_b32 v47, v22, v22, v39
  s_nop 1
  v_mfma_f32_16x16x32_bf16 v[52:55], v[44:47], v[244:247], v[52:55]
  v_perm_b32 v40, v23, v23, v32
  v_perm_b32 v41, v23, v23, v34
  v_perm_b32 v42, v23, v23, v36
  v_perm_b32 v43, v23, v23, v38
  s_nop 1
  v_mfma_f32_16x16x32_bf16 v[52:55], v[40:43], v[248:251], v[52:55]
  v_perm_b32 v44, v23, v23, v33
  v_perm_b32 v45, v23, v23, v35
  v_perm_b32 v46, v23, v23, v37
  v_perm_b32 v47, v23, v23, v39
  s_nop 1
  v_mfma_f32_16x16x32_bf16 v[52:55], v[44:47], v[252:255], v[52:55]
  s_mov_b32 exec_hi, 0
  s_nop 6
  buffer_store_dwordx4 v[52:55], v31, s[40:43], s45 offen offset:0
  ds_write_b128 v31, v[52:55] offset:3072
  s_mov_b32 exec_hi, -1
  s_waitcnt lgkmcnt(0)
  ds_write_b32 v1, v0 offset:1320
  s_branch L_V_load
L_V_other:
  s_waitcnt lgkmcnt(0)
  s_cmp_lg_u32 s32, 1
  s_cbranch_scc1 L_notouch
  s_load_dword s48, s[8:9], s33
  s_lshl_b32 s3, s29, 17
  s_load_dword s49, s[12:13], s3
  s_mul_i32 s3, s29, 44032
  s_load_dword s50, s[20:21], s3
L_notouch:
  s_barrier
  s_mov_b32 s40, s26
  s_mov_b32 s41, s27
  v_and_b32 v8, 1, v2
  v_mov_b32 v9, 0x0c0c0100
  v_mov_b32 v10, 0x01000c0c
  v_cmp_eq_u32 vcc, 1, v8
  v_mov_b32 v11, 0x0c0c0302
  v_mov_b32 v12, 0x03020c0c
  v_cndmask_b32 v9, v9, v10, vcc
  v_cndmask_b32 v11, v11, v12, vcc
  v_bfe_u32 v8, v2, 1, 3
  v_mov_b32 v10, 0x0c0c0c0c
  v_cmp_eq_u32 vcc, 0, v8
  s_nop 1
  v_cndmask_b32 v32, v10, v9, vcc
  v_cndmask_b32 v33, v10, v11, vcc
  v_cmp_eq_u32 vcc, 1, v8
  s_nop 1
  v_cndmask_b32 v34, v10, v9, vcc
  v_cndmask_b32 v35, v10, v11, vcc
  v_cmp_eq_u32 vcc, 2, v8
  s_nop 1
  v_cndmask_b32 v36, v10, v9, vcc
  v_cndmask_b32 v37, v10, v11, vcc
  v_cmp_eq_u32 vcc, 3, v8
  s_nop 1
  v_cndmask_b32 v38, v10, v9, vcc
  v_cndmask_b32 v39, v10, v11, vcc
  v_and_b32 v9, 15, v2
  v_lshlrev_b32 v9, 5, v9
  v_and_b32 v10, 16, v2
  v_add_u32 v31, v9, v10
L_V_load:
  s_mov_b32 s36, s8
  s_mov_b32 s37, s9
  v_lshrrev_b32 v8, 4, v2
  s_lshl_b32 s3, s32, 8
  v_lshl_add_u32 v28, v8, 6, s3
  s_lshl_b32 s3, s32, 3
  v_mov_b32 v29, s3
  s_lshl_b32 s3, s32, 9
  v_add_u32 v30, s3, v31
  s_mov_b32 s35, 1600000
L_gate:
  ds_read_b32 v10, v1 offset:1300
  s_waitcnt lgkmcnt(0)
  v_readfirstlane_b32 s3, v10
  s_cmp_ge_u32 s3, 4
  s_cbranch_scc1 L_gate_done
  s_sleep 1
  s_sub_u32 s35, s35, 1
  s_cmp_lg_u32 s35, 0
  s_cbranch_scc1 L_gate
L_gate_done:
  buffer_load_dwordx4 v[128:131], v3, s[36:39], s33 offen offset:0 nt
  buffer_load_dwordx4 v[132:135], v3, s[36:39], s33 offen offset:1024 nt
  buffer_load_dwordx4 v[136:139], v3, s[36:39], s33 offen offset:2048 nt
  buffer_load_dwordx4 v[140:143], v3, s[36:39], s33 offen offset:3072 nt
  s_addk_i32 s33, 0x4000
  buffer_load_dwordx4 v[144:147], v3, s[36:39], s33 offen offset:0 nt
  buffer_load_dwordx4 v[148:151], v3, s[36:39], s33 offen offset:1024 nt
  buffer_load_dwordx4 v[152:155], v3, s[36:39], s33 offen offset:2048 nt
  buffer_load_dwordx4 v[156:159], v3, s[36:39], s33 offen offset:3072 nt
  s_addk_i32 s33, 0x4000
  s_waitcnt vmcnt(7)
  buffer_load_dwordx4 v[160:163], v3, s[36:39], s33 offen offset:0 nt
  s_waitcnt vmcnt(7)
  buffer_load_dwordx4 v[164:167], v3, s[36:39], s33 offen offset:1024 nt
  s_waitcnt vmcnt(7)
  buffer_load_dwordx4 v[168:171], v3, s[36:39], s33 offen offset:2048 nt
  s_waitcnt vmcnt(7)
  buffer_load_dwordx4 v[172:175], v3, s[36:39], s33 offen offset:3072 nt
  s_addk_i32 s33, 0x4000
  s_waitcnt vmcnt(7)
  buffer_load_dwordx4 v[176:179], v3, s[36:39], s33 offen offset:0 nt
  s_waitcnt vmcnt(7)
  buffer_load_dwordx4 v[180:183], v3, s[36:39], s33 offen offset:1024 nt
  s_waitcnt vmcnt(7)
  buffer_load_dwordx4 v[184:187], v3, s[36:39], s33 offen offset:2048 nt
  s_waitcnt vmcnt(7)
  buffer_load_dwordx4 v[188:191], v3, s[36:39], s33 offen offset:3072 nt
  s_addk_i32 s33, 0x4000
  s_waitcnt vmcnt(7)
  buffer_load_dwordx4 v[192:195], v3, s[36:39], s33 offen offset:0 nt
  s_waitcnt vmcnt(7)
  buffer_load_dwordx4 v[196:199], v3, s[36:39], s33 offen offset:1024 nt
  s_waitcnt vmcnt(7)
  buffer_load_dwordx4 v[200:203], v3, s[36:39], s33 offen offset:2048 nt
  s_waitcnt vmcnt(7)
  buffer_load_dwordx4 v[204:207], v3, s[36:39], s33 offen offset:3072 nt
  s_addk_i32 s33, 0x4000
  s_waitcnt vmcnt(7)
  buffer_load_dwordx4 v[208:211], v3, s[36:39], s33 offen offset:0 nt
  s_waitcnt vmcnt(7)
  buffer_load_dwordx4 v[212:215], v3, s[36:39], s33 offen offset:1024 nt
  s_waitcnt vmcnt(7)
  buffer_load_dwordx4 v[216:219], v3, s[36:39], s33 offen offset:2048 nt
  s_waitcnt vmcnt(7)
  buffer_load_dwordx4 v[220:223], v3, s[36:39], s33 offen offset:3072 nt
  s_addk_i32 s33, 0x4000
  s_waitcnt vmcnt(7)
  buffer_load_dwordx4 v[224:227], v3, s[36:39], s33 offen offset:0 nt
  s_waitcnt vmcnt(7)
  buffer_load_dwordx4 v[228:231], v3, s[36:39], s33 offen offset:1024 nt
  s_waitcnt vmcnt(7)
  buffer_load_dwordx4 v[232:235], v3, s[36:39], s33 offen offset:2048 nt
  s_waitcnt vmcnt(7)
  buffer_load_dwordx4 v[236:239], v3, s[36:39], s33 offen offset:3072 nt
  s_addk_i32 s33, 0x4000
  s_waitcnt vmcnt(7)
  buffer_load_dwordx4 v[240:243], v3, s[36:39], s33 offen offset:0 nt
  s_waitcnt vmcnt(7)
  buffer_load_dwordx4 v[244:247], v3, s[36:39], s33 offen offset:1024 nt
  s_waitcnt vmcnt(7)
  buffer_load_dwordx4 v[248:251], v3, s[36:39], s33 offen offset:2048 nt
  s_waitcnt vmcnt(7)
  buffer_load_dwordx4 v[252:255], v3, s[36:39], s33 offen offset:3072 nt
  s_mov_b64 exec, 1
  ds_add_u32 v1, v0 offset:1308
  s_mov_b64 exec, -1
  s_mov_b32 s35, 1600000
L_pw:
  ds_read_b32 v10, v1 offset:1304
  s_waitcnt lgkmcnt(0)
  v_readfirstlane_b32 s3, v10
  s_cmp_ge_u32 s3, 4
  s_cbranch_scc1 L_pw_done
  s_sleep 1
  s_sub_u32 s35, s35, 1
  s_cmp_lg_u32 s35, 0
  s_cbranch_scc1 L_pw
L_pw_done:
  ds_read_b128 v[56:59], v28 offset:2048
  ds_read_b128 v[60:63], v28 offset:2064
  ds_read_b128 v[64:67], v28 offset:2080
  ds_read_b128 v[68:71], v28 offset:2096
  ds_read_b32 v52, v29 offset:1536
  ds_read_b128 v[8:11], v1 offset:1536
  ds_read_b128 v[12:15], v1 offset:1552
  s_waitcnt lgkmcnt(0)
  v_max_f32 v8, v8, v10
  v_max3_f32 v8, v8, v12, v14
  v_sub_f32 v52, v52, v8
  v_exp_f32 v52, v52
  v_perm_b32 v40, v56, v56, v32
  v_perm_b32 v41, v56, v56, v34
  v_perm_b32 v42, v56, v56, v36
  v_perm_b32 v43, v56, v56, v38
  s_nop 1
  v_mfma_f32_16x16x32_bf16 v[48:51], v[40:43], v[128:131], 0
  v_perm_b32 v44, v56, v56, v33
  v_perm_b32 v45, v56, v56, v35
  v_perm_b32 v46, v56, v56, v37
  v_perm_b32 v47, v56, v56, v39
  s_nop 1
  v_mfma_f32_16x16x32_bf16 v[48:51], v[44:47], v[132:135], v[48:51]
  v_perm_b32 v40, v57, v57, v32
  v_perm_b32 v41, v57, v57, v34
  v_perm_b32 v42, v57, v57, v36
  v_perm_b32 v43, v57, v57, v38
  s_nop 1
  v_mfma_f32_16x16x32_bf16 v[48:51], v[40:43], v[136:139], v[48:51]
  v_perm_b32 v44, v57, v57, v33
  v_perm_b32 v45, v57, v57, v35
  v_perm_b32 v46, v57, v57, v37
  v_perm_b32 v47, v57, v57, v39
  s_nop 1
  v_mfma_f32_16x16x32_bf16 v[48:51], v[44:47], v[140:143], v[48:51]
  v_perm_b32 v40, v58, v58, v32
  v_perm_b32 v41, v58, v58, v34
  v_perm_b32 v42, v58, v58, v36
  v_perm_b32 v43, v58, v58, v38
  s_nop 1
  v_mfma_f32_16x16x32_bf16 v[48:51], v[40:43], v[144:147], v[48:51]
  v_perm_b32 v44, v58, v58, v33
  v_perm_b32 v45, v58, v58, v35
  v_perm_b32 v46, v58, v58, v37
  v_perm_b32 v47, v58, v58, v39
  s_nop 1
  v_mfma_f32_16x16x32_bf16 v[48:51], v[44:47], v[148:151], v[48:51]
  v_perm_b32 v40, v59, v59, v32
  v_perm_b32 v41, v59, v59, v34
  v_perm_b32 v42, v59, v59, v36
  v_perm_b32 v43, v59, v59, v38
  s_nop 1
  v_mfma_f32_16x16x32_bf16 v[48:51], v[40:43], v[152:155], v[48:51]
  v_perm_b32 v44, v59, v59, v33
  v_perm_b32 v45, v59, v59, v35
  v_perm_b32 v46, v59, v59, v37
  v_perm_b32 v47, v59, v59, v39
  s_nop 1
  v_mfma_f32_16x16x32_bf16 v[48:51], v[44:47], v[156:159], v[48:51]
  v_perm_b32 v40, v60, v60, v32
  v_perm_b32 v41, v60, v60, v34
  v_perm_b32 v42, v60, v60, v36
  v_perm_b32 v43, v60, v60, v38
  s_nop 1
  v_mfma_f32_16x16x32_bf16 v[48:51], v[40:43], v[160:163], v[48:51]
  v_perm_b32 v44, v60, v60, v33
  v_perm_b32 v45, v60, v60, v35
  v_perm_b32 v46, v60, v60, v37
  v_perm_b32 v47, v60, v60, v39
  s_nop 1
  v_mfma_f32_16x16x32_bf16 v[48:51], v[44:47], v[164:167], v[48:51]
  v_perm_b32 v40, v61, v61, v32
  v_perm_b32 v41, v61, v61, v34
  v_perm_b32 v42, v61, v61, v36
  v_perm_b32 v43, v61, v61, v38
  s_nop 1
  v_mfma_f32_16x16x32_bf16 v[48:51], v[40:43], v[168:171], v[48:51]
  v_perm_b32 v44, v61, v61, v33
  v_perm_b32 v45, v61, v61, v35
  v_perm_b32 v46, v61, v61, v37
  v_perm_b32 v47, v61, v61, v39
  s_nop 1
  v_mfma_f32_16x16x32_bf16 v[48:51], v[44:47], v[172:175], v[48:51]
  v_perm_b32 v40, v62, v62, v32
  v_perm_b32 v41, v62, v62, v34
  v_perm_b32 v42, v62, v62, v36
  v_perm_b32 v43, v62, v62, v38
  s_nop 1
  v_mfma_f32_16x16x32_bf16 v[48:51], v[40:43], v[176:179], v[48:51]
  v_perm_b32 v44, v62, v62, v33
  v_perm_b32 v45, v62, v62, v35
  v_perm_b32 v46, v62, v62, v37
  v_perm_b32 v47, v62, v62, v39
  s_nop 1
  v_mfma_f32_16x16x32_bf16 v[48:51], v[44:47], v[180:183], v[48:51]
  v_perm_b32 v40, v63, v63, v32
  v_perm_b32 v41, v63, v63, v34
  v_perm_b32 v42, v63, v63, v36
  v_perm_b32 v43, v63, v63, v38
  s_nop 1
  v_mfma_f32_16x16x32_bf16 v[48:51], v[40:43], v[184:187], v[48:51]
  v_perm_b32 v44, v63, v63, v33
  v_perm_b32 v45, v63, v63, v35
  v_perm_b32 v46, v63, v63, v37
  v_perm_b32 v47, v63, v63, v39
  s_nop 1
  v_mfma_f32_16x16x32_bf16 v[48:51], v[44:47], v[188:191], v[48:51]
  v_perm_b32 v40, v64, v64, v32
  v_perm_b32 v41, v64, v64, v34
  v_perm_b32 v42, v64, v64, v36
  v_perm_b32 v43, v64, v64, v38
  s_nop 1
  v_mfma_f32_16x16x32_bf16 v[48:51], v[40:43], v[192:195], v[48:51]
  v_perm_b32 v44, v64, v64, v33
  v_perm_b32 v45, v64, v64, v35
  v_perm_b32 v46, v64, v64, v37
  v_perm_b32 v47, v64, v64, v39
  s_nop 1
  v_mfma_f32_16x16x32_bf16 v[48:51], v[44:47], v[196:199], v[48:51]
  v_perm_b32 v40, v65, v65, v32
  v_perm_b32 v41, v65, v65, v34
  v_perm_b32 v42, v65, v65, v36
  v_perm_b32 v43, v65, v65, v38
  s_nop 1
  v_mfma_f32_16x16x32_bf16 v[48:51], v[40:43], v[200:203], v[48:51]
  v_perm_b32 v44, v65, v65, v33
  v_perm_b32 v45, v65, v65, v35
  v_perm_b32 v46, v65, v65, v37
  v_perm_b32 v47, v65, v65, v39
  s_nop 1
  v_mfma_f32_16x16x32_bf16 v[48:51], v[44:47], v[204:207], v[48:51]
  v_perm_b32 v40, v66, v66, v32
  v_perm_b32 v41, v66, v66, v34
  v_perm_b32 v42, v66, v66, v36
  v_perm_b32 v43, v66, v66, v38
  s_nop 1
  v_mfma_f32_16x16x32_bf16 v[48:51], v[40:43], v[208:211], v[48:51]
  v_perm_b32 v44, v66, v66, v33
  v_perm_b32 v45, v66, v66, v35
  v_perm_b32 v46, v66, v66, v37
  v_perm_b32 v47, v66, v66, v39
  s_nop 1
  v_mfma_f32_16x16x32_bf16 v[48:51], v[44:47], v[212:215], v[48:51]
  v_perm_b32 v40, v67, v67, v32
  v_perm_b32 v41, v67, v67, v34
  v_perm_b32 v42, v67, v67, v36
  v_perm_b32 v43, v67, v67, v38
  s_nop 1
  v_mfma_f32_16x16x32_bf16 v[48:51], v[40:43], v[216:219], v[48:51]
  v_perm_b32 v44, v67, v67, v33
  v_perm_b32 v45, v67, v67, v35
  v_perm_b32 v46, v67, v67, v37
  v_perm_b32 v47, v67, v67, v39
  s_nop 1
  v_mfma_f32_16x16x32_bf16 v[48:51], v[44:47], v[220:223], v[48:51]
  v_perm_b32 v40, v68, v68, v32
  v_perm_b32 v41, v68, v68, v34
  v_perm_b32 v42, v68, v68, v36
  v_perm_b32 v43, v68, v68, v38
  s_nop 0
  s_waitcnt vmcnt(7)
  v_mfma_f32_16x16x32_bf16 v[48:51], v[40:43], v[224:227], v[48:51]
  v_perm_b32 v44, v68, v68, v33
  v_perm_b32 v45, v68, v68, v35
  v_perm_b32 v46, v68, v68, v37
  v_perm_b32 v47, v68, v68, v39
  s_nop 0
  s_waitcnt vmcnt(6)
  v_mfma_f32_16x16x32_bf16 v[48:51], v[44:47], v[228:231], v[48:51]
  v_perm_b32 v40, v69, v69, v32
  v_perm_b32 v41, v69, v69, v34
  v_perm_b32 v42, v69, v69, v36
  v_perm_b32 v43, v69, v69, v38
  s_nop 0
  s_waitcnt vmcnt(5)
  v_mfma_f32_16x16x32_bf16 v[48:51], v[40:43], v[232:235], v[48:51]
  v_perm_b32 v44, v69, v69, v33
  v_perm_b32 v45, v69, v69, v35
  v_perm_b32 v46, v69, v69, v37
  v_perm_b32 v47, v69, v69, v39
  s_nop 0
  s_waitcnt vmcnt(4)
  v_mfma_f32_16x16x32_bf16 v[48:51], v[44:47], v[236:239], v[48:51]
  v_perm_b32 v40, v70, v70, v32
  v_perm_b32 v41, v70, v70, v34
  v_perm_b32 v42, v70, v70, v36
  v_perm_b32 v43, v70, v70, v38
  s_nop 0
  s_waitcnt vmcnt(3)
  v_mfma_f32_16x16x32_bf16 v[48:51], v[40:43], v[240:243], v[48:51]
  v_perm_b32 v44, v70, v70, v33
  v_perm_b32 v45, v70, v70, v35
  v_perm_b32 v46, v70, v70, v37
  v_perm_b32 v47, v70, v70, v39
  s_nop 0
  s_waitcnt vmcnt(2)
  v_mfma_f32_16x16x32_bf16 v[48:51], v[44:47], v[244:247], v[48:51]
  v_perm_b32 v40, v71, v71, v32
  v_perm_b32 v41, v71, v71, v34
  v_perm_b32 v42, v71, v71, v36
  v_perm_b32 v43, v71, v71, v38
  s_nop 0
  s_waitcnt vmcnt(1)
  v_mfma_f32_16x16x32_bf16 v[48:51], v[40:43], v[248:251], v[48:51]
  v_perm_b32 v44, v71, v71, v33
  v_perm_b32 v45, v71, v71, v35
  v_perm_b32 v46, v71, v71, v37
  v_perm_b32 v47, v71, v71, v39
  s_nop 0
  s_waitcnt vmcnt(0)
  v_mfma_f32_16x16x32_bf16 v[48:51], v[44:47], v[252:255], v[48:51]
  s_mov_b32 exec_hi, 0
  s_nop 6
  v_mul_f32 v48, v48, v52
  v_mul_f32 v49, v49, v52
  v_mul_f32 v50, v50, v52
  v_mul_f32 v51, v51, v52
  ds_write_b128 v30, v[48:51] offset:8192
  s_waitcnt lgkmcnt(0)
  s_barrier
L_last:
  s_endpgm
.section .rodata,"a"
.p2align 6
.amdhsa_kernel parallel_sum__gqa_block_cached__geglu_ffn__decode_kernel
  .amdhsa_next_free_vgpr 256
  .amdhsa_next_free_sgpr 96
  .amdhsa_accum_offset 256
  .amdhsa_group_segment_fixed_size 0
  .amdhsa_kernarg_size 96
  .amdhsa_user_sgpr_count 2
  .amdhsa_user_sgpr_kernarg_segment_ptr 1
  .amdhsa_system_sgpr_workgroup_id_x 1
.end_amdhsa_kernel
```
